```python
import torch

def _softmax(x, axis=-1):
    return torch.softmax(x, dim=axis)
def _gelu(x):
    return torch.nn.functional.gelu(x, approximate="tanh")
def _silu(x):
    return torch.nn.functional.silu(x)
def _sigmoid(x):
    return torch.sigmoid(x)
def _layernorm(x, axis=-1, eps=1e-5):
    m = x.mean(dim=axis, keepdim=True)
    v = x.var(dim=axis, keepdim=True, unbiased=False)
    return (x - m) / torch.sqrt(v + eps)
def _scatter_add(tgt, idx, src, axis=0):
    return tgt.clone().index_add_(axis, idx, src)
def _segment_sum(src, seg, n):
    out = torch.zeros((n,) + src.shape[1:], dtype=src.dtype)
    return out.index_add_(0, seg, src)
def _pad(x, pw):
    flat = tuple(v for pair in reversed(pw) for v in pair)
    return torch.nn.functional.pad(x, flat)

kernel_name = 'gather_scatter__cheap_equivariant_egnn__graph'

def setup_inputs():

    _w = (lambda a: (lambda t: t.to(torch.bfloat16) if t.is_floating_point() else t)(torch.as_tensor(a)))
    N, deg, D, De = 10000, 32, 128, max(0, 1)
    E = N * deg
    return {
        "h": _w((lambda *s: torch.randn(*s, dtype=torch.bfloat16) * 0.2)(N, D)),
        "pos": _w((lambda *s: torch.randn(*s, dtype=torch.bfloat16) * 0.8)(N, 3)),
        "e_attr": _w((lambda *s: torch.randn(*s, dtype=torch.bfloat16) * 0.8)(E, De)),
        "src": _w((lambda lo, hi, *s: torch.randint(lo, hi, s))(0, N, E).to(torch.int64)),
        "dst": _w((lambda lo, hi, *s: torch.randint(lo, hi, s))(0, N, E).to(torch.int64)),
        "w_e": _w(0.1 * (lambda *s: torch.randn(*s, dtype=torch.bfloat16) * 0.8)(2 * D + 1 + De, D)),
        "w_x": _w(0.1 * (lambda *s: torch.randn(*s, dtype=torch.bfloat16) * 0.2)(D, 1)),
        "w_h": _w(0.1 * (lambda *s: torch.randn(*s, dtype=torch.bfloat16) * 0.2)(2 * D, D)),
    }

def reference(h, pos, e_attr, src, dst, w_e, w_x, w_h):
    N, D = h.shape[0], h.shape[1]
    diff = pos[dst] - pos[src]
    dist2 = torch.sum(diff * diff, axis=-1, keepdims=True)
    e_in = torch.concatenate([h[dst], h[src], dist2, e_attr], axis=-1)
    m_ij = _silu(e_in @ w_e)
    coord_scale = m_ij @ w_x
    pos_new = pos + _segment_sum(diff * coord_scale, dst, N)
    m_i = _segment_sum(m_ij, dst, N)
    h_new = h + _silu(torch.concatenate([h, m_i], axis=-1) @ w_h)
    return h_new, pos_new
```

```asm
; @launch kernel=egnn_prep_kernel grid=(256,1,1) block=(512,1,1) lds=81920
; @launch kernel=egnn_main_kernel grid=(256,1,1) block=(1024,1,1) lds=163840
.amdgcn_target "amdgcn-amd-amdhsa--gfx950"
.text
.globl egnn_prep_kernel
.p2align 8
.type egnn_prep_kernel,@function
egnn_prep_kernel:
    s_load_dwordx16 s[4:19], s[0:1], 0
    s_load_dwordx2 s[20:21], s[0:1], 80
    v_lshrrev_b32 v1, 6, v0
    v_and_b32 v2, 63, v0
    v_readfirstlane_b32 s3, v1
    s_cmp_ge_u32 s2, 125
    s_cbranch_scc1 .K1_notS
    v_mov_b32 v3, 0
    v_lshlrev_b32 v4, 2, v0
    ds_write_b32 v4, v3 offset:0
    v_lshlrev_b32 v5, 4, v0
    v_lshlrev_b32 v6, 3, v0
    v_lshlrev_b32 v7, 1, v0
    v_lshlrev_b32 v25, 4, v2
    s_mul_i32 s40, s2, 10240
    s_add_u32 s41, s40, 8192
    s_mul_i32 s42, s2, 5120
    s_add_u32 s44, s42, 4096
    s_lshr_b32 s43, s2, 3
    s_lshl_b32 s43, s43, 12
    s_waitcnt lgkmcnt(0)
    s_mov_b32 s24, s12
    s_and_b32 s25, s13, 0xffff
    s_mov_b32 s26, 1280000
    s_mov_b32 s27, 0x00020000
    buffer_load_dwordx4 v[8:11], v5, s[24:27], s40 offen nt
    buffer_load_dword v12, v4, s[24:27], s41 offen nt
    s_mov_b32 s56, s14
    s_and_b32 s57, s15, 0xffff
    s_mov_b32 s58, 65536
    s_mov_b32 s59, 0x00020000
    s_lshr_b32 s47, s43, 1
    s_add_u32 s47, s47, 32768
    buffer_load_dword v21, v4, s[56:59], s47 offen
    s_barrier
    s_mov_b32 s28, s10
    s_and_b32 s29, s11, 0xffff
    s_mov_b32 s30, 1280000
    s_mov_b32 s31, 0x00020000
    buffer_load_dwordx4 v[16:19], v5, s[28:31], s40 offen nt
    buffer_load_dword v20, v4, s[28:31], s41 offen nt
    s_mov_b32 s32, s8
    s_and_b32 s33, s9, 0xffff
    s_mov_b32 s34, 640000
    s_mov_b32 s35, 0x00020000
    buffer_load_dwordx2 v[22:23], v6, s[32:35], s42 offen nt
    buffer_load_short_d16_hi v24, v7, s[32:35], s44 offen nt
    s_mov_b32 s36, s6
    s_and_b32 s37, s7, 0xffff
    s_mov_b32 s38, 60000
    s_mov_b32 s39, 0x00020000
    buffer_load_dwordx2 v[14:15], v6, s[36:39], s43 offen
    v_mov_b32 v3, 8
    s_movk_i32 s44, -625
    s_mov_b32 s45, 0xfffc
    s_mov_b32 s46, 8389632
    s_add_u32 s48, s20, 5242880
    s_addc_u32 s49, s21, 0
    s_and_b32 s49, s49, 0xffff
    s_mov_b32 s50, 2560000
    s_mov_b32 s51, 0x00020000
    s_add_u32 s52, s20, 10485760
    s_addc_u32 s53, s21, 0
    s_and_b32 s53, s53, 0xffff
    s_mov_b32 s54, 131072
    s_mov_b32 s55, 0x00020000
    s_mul_i32 s40, s2, 20480
    s_add_u32 s42, s40, 8192
    s_add_u32 s43, s40, 16384
    s_lshl_b32 s41, s2, 4
    v_lshlrev_b32 v13, 11, v2
    s_waitcnt vmcnt(6)
    v_mul_u32_u24 v41, 429497, v8
    v_mul_u32_u24 v42, 429497, v9
    v_mul_u32_u24 v43, 429497, v10
    v_mul_u32_u24 v44, 429497, v11
    v_mul_u32_u24 v45, 429497, v12
    v_lshrrev_b32 v41, 24, v41
    v_lshrrev_b32 v42, 24, v42
    v_lshrrev_b32 v43, 24, v43
    v_lshrrev_b32 v44, 24, v44
    v_lshrrev_b32 v45, 24, v45
    v_lshlrev_b32 v26, 2, v41
    ds_add_rtn_u32 v31, v26, v3 offset:0
    v_lshlrev_b32 v27, 2, v42
    ds_add_rtn_u32 v32, v27, v3 offset:0
    v_lshlrev_b32 v28, 2, v43
    ds_add_rtn_u32 v33, v28, v3 offset:0
    v_lshlrev_b32 v29, 2, v44
    ds_add_rtn_u32 v34, v29, v3 offset:0
    v_lshlrev_b32 v30, 2, v45
    ds_add_rtn_u32 v35, v30, v3 offset:0
    v_mul_i32_i24 v41, s44, v41
    v_ashrrev_i32 v41, 4, v41
    v_add_lshl_u32 v8, v8, v41, 10
    v_mul_i32_i24 v42, s44, v42
    v_ashrrev_i32 v42, 4, v42
    v_add_lshl_u32 v9, v9, v42, 10
    v_mul_i32_i24 v43, s44, v43
    v_ashrrev_i32 v43, 4, v43
    v_add_lshl_u32 v10, v10, v43, 10
    v_mul_i32_i24 v44, s44, v44
    v_ashrrev_i32 v44, 4, v44
    v_add_lshl_u32 v11, v11, v44, 10
    v_mul_i32_i24 v45, s44, v45
    v_ashrrev_i32 v45, 4, v45
    v_add_lshl_u32 v12, v12, v45, 10
    s_waitcnt lgkmcnt(0)
    s_barrier
    ds_read_b128 v[48:51], v25 offset:0
    s_waitcnt lgkmcnt(0)
    v_add_u32 v54, v48, v49
    v_add_u32 v55, v54, v50
    v_add_u32 v56, v55, v51
    v_mov_b32 v57, v56
    s_nop 1
    v_add_u32_dpp v57, v57, v57 row_shr:1 row_mask:0xf bank_mask:0xf
    s_nop 1
    v_add_u32_dpp v57, v57, v57 row_shr:2 row_mask:0xf bank_mask:0xf
    s_nop 1
    v_add_u32_dpp v57, v57, v57 row_shr:4 row_mask:0xf bank_mask:0xf
    s_nop 1
    v_add_u32_dpp v57, v57, v57 row_shr:8 row_mask:0xf bank_mask:0xf
    s_nop 1
    v_add_u32_dpp v57, v57, v57 row_bcast:15 row_mask:0xa bank_mask:0xf
    s_nop 1
    v_add_u32_dpp v57, v57, v57 row_bcast:31 row_mask:0xc bank_mask:0xf
    v_sub_u32 v52, v57, v56
    v_add_u32 v53, v52, v48
    v_add_u32 v54, v52, v54
    v_add_u32 v55, v52, v55
    ds_write_b128 v25, v[52:55] offset:1024
    ds_read_b32 v26, v26 offset:1024
    ds_read_b32 v27, v27 offset:1024
    ds_read_b32 v28, v28 offset:1024
    ds_read_b32 v29, v29 offset:1024
    ds_read_b32 v30, v30 offset:1024
    s_waitcnt vmcnt(3)
    v_lshl_add_u32 v36, v16, 16, s46
    v_mul_u32_u24 v41, 6, v16
    v_add_u32 v36, v36, v8
    v_add_u32 v31, 2048, v31
    v_lshlrev_b32_sdwa v36, 4, v16 dst_sel:BYTE_0 dst_unused:UNUSED_PRESERVE src0_sel:DWORD src1_sel:DWORD
    v_lshl_add_u32 v37, v17, 16, s46
    v_mul_u32_u24 v42, 6, v17
    v_add_u32 v37, v37, v9
    v_add_u32 v32, 2048, v32
    v_lshlrev_b32_sdwa v37, 4, v17 dst_sel:BYTE_0 dst_unused:UNUSED_PRESERVE src0_sel:DWORD src1_sel:DWORD
    v_lshl_add_u32 v38, v18, 16, s46
    v_mul_u32_u24 v43, 6, v18
    v_add_u32 v38, v38, v10
    v_add_u32 v33, 2048, v33
    v_lshlrev_b32_sdwa v38, 4, v18 dst_sel:BYTE_0 dst_unused:UNUSED_PRESERVE src0_sel:DWORD src1_sel:DWORD
    v_lshl_add_u32 v39, v19, 16, s46
    v_mul_u32_u24 v44, 6, v19
    v_add_u32 v39, v39, v11
    v_add_u32 v34, 2048, v34
    v_lshlrev_b32_sdwa v39, 4, v19 dst_sel:BYTE_0 dst_unused:UNUSED_PRESERVE src0_sel:DWORD src1_sel:DWORD
    v_lshl_add_u32 v40, v20, 16, s46
    v_mul_u32_u24 v45, 6, v20
    v_add_u32 v40, v40, v12
    v_add_u32 v35, 2048, v35
    v_lshlrev_b32_sdwa v40, 4, v20 dst_sel:BYTE_0 dst_unused:UNUSED_PRESERVE src0_sel:DWORD src1_sel:DWORD
    v_lshl_or_b32 v48, v48, 13, v52
    v_lshl_or_b32 v49, v49, 13, v53
    v_lshl_or_b32 v50, v50, 13, v54
    v_lshl_or_b32 v51, v51, 13, v55
    s_cmp_lg_u32 s3, 0
    s_cbranch_scc1 .K1_notab
    buffer_store_dwordx4 v[48:51], v13, s[52:55], s41 offen sc1
    s_waitcnt vmcnt(2)
    s_branch .K1_tab
.K1_notab:
    s_waitcnt vmcnt(1)
.K1_tab:
    v_lshlrev_b32 v46, 16, v22
    v_lshlrev_b32 v47, 16, v23
    v_and_b32_sdwa v46, s45, v41 dst_sel:WORD_0 dst_unused:UNUSED_PRESERVE src0_sel:DWORD src1_sel:DWORD
    v_and_b32_sdwa v22, s45, v42 dst_sel:WORD_0 dst_unused:UNUSED_PRESERVE src0_sel:DWORD src1_sel:DWORD
    v_and_b32_sdwa v47, s45, v43 dst_sel:WORD_0 dst_unused:UNUSED_PRESERVE src0_sel:DWORD src1_sel:DWORD
    v_and_b32_sdwa v23, s45, v44 dst_sel:WORD_0 dst_unused:UNUSED_PRESERVE src0_sel:DWORD src1_sel:DWORD
    v_and_b32_sdwa v24, s45, v45 dst_sel:WORD_0 dst_unused:UNUSED_PRESERVE src0_sel:DWORD src1_sel:DWORD
    s_waitcnt lgkmcnt(0)
    v_add_u32 v26, v31, v26
    ds_write2_b32 v26, v46, v36 offset0:0 offset1:1
    v_add_u32 v27, v32, v27
    ds_write2_b32 v27, v22, v37 offset0:0 offset1:1
    v_add_u32 v28, v33, v28
    ds_write2_b32 v28, v47, v38 offset0:0 offset1:1
    v_add_u32 v29, v34, v29
    ds_write2_b32 v29, v23, v39 offset0:0 offset1:1
    v_add_u32 v30, v35, v30
    ds_write2_b32 v30, v24, v40 offset0:0 offset1:1
    s_waitcnt lgkmcnt(0)
    s_barrier
    ds_read_b128 v[64:67], v5 offset:2048
    ds_read_b128 v[68:71], v5 offset:10240
    ds_read_b64 v[72:73], v6 offset:18432
    s_waitcnt lgkmcnt(2)
    buffer_store_dwordx4 v[64:67], v5, s[48:51], s40 offen sc1
    s_waitcnt lgkmcnt(1)
    buffer_store_dwordx4 v[68:71], v5, s[48:51], s42 offen sc1
    s_waitcnt lgkmcnt(0)
    buffer_store_dwordx2 v[72:73], v6, s[48:51], s43 offen sc1
    s_waitcnt vmcnt(3)
    s_endpgm
.K1_notS:
    s_cmp_ge_u32 s2, 254
    s_cbranch_scc1 .K1_end
    v_lshrrev_b32 v3, 4, v2
    v_and_b32 v4, 15, v2
    v_lshlrev_b32 v5, 2, v3
    v_xor_b32 v5, v5, v4
    v_lshlrev_b32 v5, 4, v5
    v_lshl_or_b32 v5, v3, 8, v5
    s_cmp_lt_u32 s2, 128
    s_cbranch_scc1 .K1_W
    s_cmp_eq_u32 s2, 253
    s_cbranch_scc1 .K1_M
    s_sub_u32 s40, s2, 128
    s_mul_i32 s40, s40, 20480
    s_lshl_b32 s44, s3, 10
    s_add_u32 s45, s44, 32768
    s_mov_b32 m0, s45
    s_and_b32 s46, s3, 3
    s_lshl_b32 s46, s46, 2
    v_or_b32 v6, s46, v3
    v_xor_b32 v6, v6, v4
    v_lshlrev_b32 v6, 4, v6
    v_lshl_or_b32 v6, v3, 8, v6
    s_add_u32 s47, s40, s44
    s_add_u32 s48, s47, 8192
    s_add_u32 s49, s47, 16384
    s_add_u32 s43, s44, 32768
    s_waitcnt lgkmcnt(0)
    s_mov_b32 s28, s4
    s_and_b32 s29, s5, 0xffff
    s_mov_b32 s30, 2560000
    s_mov_b32 s31, 0x00020000
    buffer_load_dwordx4 v6, s[28:31], s47 offen nt lds
    s_add_u32 s45, s45, 8192
    s_mov_b32 m0, s45
    s_mov_b32 s24, s14
    s_and_b32 s25, s15, 0xffff
    s_mov_b32 s26, 65536
    s_mov_b32 s27, 0x00020000
    buffer_load_dwordx4 v6, s[28:31], s48 offen nt lds
    s_cmp_ge_u32 s3, 4
    s_cbranch_scc1 .K1_g1
    s_add_u32 s45, s45, 8192
    s_mov_b32 m0, s45
    s_nop 0
    buffer_load_dwordx4 v6, s[28:31], s49 offen nt lds
.K1_g1:
    s_mov_b32 m0, s44
    s_add_u32 s44, s44, 8192
    buffer_load_dwordx4 v5, s[24:27], s43 offen lds
    s_add_u32 s43, s43, 8192
    s_mov_b32 m0, s44
    s_add_u32 s44, s44, 8192
    s_barrier
    buffer_load_dwordx4 v5, s[24:27], s43 offen lds
    s_add_u32 s43, s43, 8192
    s_mov_b32 m0, s44
    s_add_u32 s44, s44, 8192
    buffer_load_dwordx4 v5, s[24:27], s43 offen lds
    s_add_u32 s43, s43, 8192
    s_mov_b32 m0, s44
    s_add_u32 s44, s44, 8192
    buffer_load_dwordx4 v5, s[24:27], s43 offen lds
    s_add_u32 s43, s43, 8192
    s_add_u32 s32, s20, 33792
    s_addc_u32 s33, s21, 0
    s_and_b32 s33, s33, 0xffff
    s_mov_b32 s34, 2560000
    s_mov_b32 s35, 0x00020000
    s_lshl_b32 s46, s3, 10
    s_add_u32 s46, s46, 53248
    v_lshlrev_b32 v8, 4, v2
    v_add_u32 v8, s46, v8
    s_cmp_lt_u32 s3, 4
    s_cbranch_scc1 .K1_gc
    s_getpc_b64 s[96:97]
.K1_pc5:
    s_bfe_u32 s98, s2, 0x40003
    s_and_b32 s99, s3, 3
    s_lshl2_add_u32 s98, s98, s99
    s_lshl_b32 s98, s98, 7
    s_add_u32 s98, s98, egnn_main_kernel-.K1_pc5
    s_load_dword s99, s[96:97], s98
    s_waitcnt vmcnt(3)
    s_barrier
    s_waitcnt vmcnt(2)
    s_barrier
    s_waitcnt vmcnt(1)
    s_barrier
    s_waitcnt vmcnt(0)
    s_barrier
    s_barrier
    ds_read_b128 v[32:35], v8
    ds_read_b128 v[36:39], v8 offset:8192
    s_waitcnt lgkmcnt(1)
    buffer_store_dwordx4 v[32:35], v6, s[32:35], s47 offen sc1
    s_waitcnt lgkmcnt(0)
    buffer_store_dwordx4 v[36:39], v6, s[32:35], s48 offen sc1
    s_endpgm
.K1_gc:
    v_bfe_u32 v9, v2, 2, 2
    v_lshl_add_u32 v10, v3, 3, v9
    v_lshlrev_b32 v10, 8, v10
    v_xor_b32 v11, s3, v9
    v_lshl_or_b32 v10, v11, 6, v10
    v_and_b32 v11, 3, v2
    v_lshl_or_b32 v10, v11, 4, v10
    v_xor_b32 v12, v3, v4
    v_lshlrev_b32 v12, 4, v12
    v_lshl_or_b32 v12, v4, 8, v12
    v_add_u32 v12, 32768, v12
    s_lshl_b32 s46, s3, 6
    v_xor_b32 v7, s46, v12
    v_xor_b32 v13, 64, v12
    v_xor_b32 v14, 128, v12
    v_xor_b32 v15, 192, v12
    s_mov_b32 s56, 3216550459
    s_mov_b32 s57, 3216550459
    s_waitcnt vmcnt(3)
    s_barrier
    ds_read_b64_tr_b16 v[16:17], v10 offset:0
    ds_read_b64_tr_b16 v[18:19], v10 offset:1024
    ds_read_b64_tr_b16 v[20:21], v10 offset:8
    ds_read_b64_tr_b16 v[22:23], v10 offset:1032
    ds_read_b128 v[32:35], v12 offset:0
    ds_read_b128 v[48:51], v12 offset:4096
    ds_read_b128 v[64:67], v12 offset:8192
    ds_read_b128 v[80:83], v12 offset:12288
    ds_read_b128 v[96:99], v12 offset:16384
    ds_read_b128 v[36:39], v13 offset:0
    ds_read_b128 v[52:55], v13 offset:4096
    ds_read_b128 v[68:71], v13 offset:8192
    ds_read_b128 v[84:87], v13 offset:12288
    ds_read_b128 v[100:103], v13 offset:16384
    s_waitcnt vmcnt(2)
    s_barrier
    s_waitcnt lgkmcnt(5)
    ds_read_b64_tr_b16 v[24:25], v10 offset:8192
    ds_read_b64_tr_b16 v[26:27], v10 offset:9216
    ds_read_b64_tr_b16 v[28:29], v10 offset:8200
    ds_read_b64_tr_b16 v[30:31], v10 offset:9224
    ds_read_b128 v[40:43], v14 offset:0
    ds_read_b128 v[56:59], v14 offset:4096
    ds_read_b128 v[72:75], v14 offset:8192
    ds_read_b128 v[88:91], v14 offset:12288
    ds_read_b128 v[104:107], v14 offset:16384
    v_mfma_f32_16x16x32_bf16 v[112:115], v[16:19], v[32:35], 0
    v_mfma_f32_16x16x32_bf16 v[116:119], v[20:23], v[32:35], 0
    v_mfma_f32_16x16x32_bf16 v[120:123], v[16:19], v[48:51], 0
    v_mfma_f32_16x16x32_bf16 v[124:127], v[20:23], v[48:51], 0
    v_mfma_f32_16x16x32_bf16 v[128:131], v[16:19], v[64:67], 0
    v_mfma_f32_16x16x32_bf16 v[132:135], v[20:23], v[64:67], 0
    v_mfma_f32_16x16x32_bf16 v[136:139], v[16:19], v[80:83], 0
    v_mfma_f32_16x16x32_bf16 v[140:143], v[20:23], v[80:83], 0
    v_mfma_f32_16x16x32_bf16 v[144:147], v[16:19], v[96:99], 0
    v_mfma_f32_16x16x32_bf16 v[148:151], v[20:23], v[96:99], 0
    s_waitcnt vmcnt(1)
    s_barrier
    s_waitcnt lgkmcnt(5)
    v_mfma_f32_16x16x32_bf16 v[112:115], v[24:27], v[36:39], v[112:115]
    v_mfma_f32_16x16x32_bf16 v[116:119], v[28:31], v[36:39], v[116:119]
    ds_read_b64_tr_b16 v[16:17], v10 offset:16384
    ds_read_b64_tr_b16 v[18:19], v10 offset:17408
    ds_read_b64_tr_b16 v[20:21], v10 offset:16392
    ds_read_b64_tr_b16 v[22:23], v10 offset:17416
    ds_read_b128 v[44:47], v15 offset:0
    ds_read_b128 v[60:63], v15 offset:4096
    ds_read_b128 v[76:79], v15 offset:8192
    ds_read_b128 v[92:95], v15 offset:12288
    ds_read_b128 v[108:111], v15 offset:16384
    v_mfma_f32_16x16x32_bf16 v[120:123], v[24:27], v[52:55], v[120:123]
    v_mfma_f32_16x16x32_bf16 v[124:127], v[28:31], v[52:55], v[124:127]
    v_mfma_f32_16x16x32_bf16 v[128:131], v[24:27], v[68:71], v[128:131]
    v_mfma_f32_16x16x32_bf16 v[132:135], v[28:31], v[68:71], v[132:135]
    v_mfma_f32_16x16x32_bf16 v[136:139], v[24:27], v[84:87], v[136:139]
    v_mfma_f32_16x16x32_bf16 v[140:143], v[28:31], v[84:87], v[140:143]
    v_mfma_f32_16x16x32_bf16 v[144:147], v[24:27], v[100:103], v[144:147]
    v_mfma_f32_16x16x32_bf16 v[148:151], v[28:31], v[100:103], v[148:151]
    s_waitcnt vmcnt(0)
    s_barrier
    ds_read_b64_tr_b16 v[24:25], v10 offset:24576
    ds_read_b64_tr_b16 v[26:27], v10 offset:25600
    ds_read_b64_tr_b16 v[28:29], v10 offset:24584
    ds_read_b64_tr_b16 v[30:31], v10 offset:25608
    s_waitcnt lgkmcnt(9)
    v_mfma_f32_16x16x32_bf16 v[112:115], v[16:19], v[40:43], v[112:115]
    v_mfma_f32_16x16x32_bf16 v[116:119], v[20:23], v[40:43], v[116:119]
    v_mfma_f32_16x16x32_bf16 v[120:123], v[16:19], v[56:59], v[120:123]
    v_mfma_f32_16x16x32_bf16 v[124:127], v[20:23], v[56:59], v[124:127]
    v_mfma_f32_16x16x32_bf16 v[128:131], v[16:19], v[72:75], v[128:131]
    v_mfma_f32_16x16x32_bf16 v[132:135], v[20:23], v[72:75], v[132:135]
    s_waitcnt lgkmcnt(0)
    v_mfma_f32_16x16x32_bf16 v[112:115], v[24:27], v[44:47], v[112:115]
    v_mfma_f32_16x16x32_bf16 v[116:119], v[28:31], v[44:47], v[116:119]
    v_mfma_f32_16x16x32_bf16 v[120:123], v[24:27], v[60:63], v[120:123]
    v_mfma_f32_16x16x32_bf16 v[124:127], v[28:31], v[60:63], v[124:127]
    v_mfma_f32_16x16x32_bf16 v[136:139], v[16:19], v[88:91], v[136:139]
    v_mfma_f32_16x16x32_bf16 v[140:143], v[20:23], v[88:91], v[140:143]
    s_nop 2
    v_pk_mul_f32 v[112:113], v[112:113], s[56:57]
    v_pk_mul_f32 v[114:115], v[114:115], s[56:57]
    v_pk_mul_f32 v[116:117], v[116:117], s[56:57]
    v_pk_mul_f32 v[118:119], v[118:119], s[56:57]
    v_cvt_pk_bf16_f32 v36, v112, v113
    v_cvt_pk_bf16_f32 v37, v114, v115
    v_cvt_pk_bf16_f32 v38, v116, v117
    v_cvt_pk_bf16_f32 v39, v118, v119
    ds_write_b128 v7, v[36:39] offset:20480
    v_mfma_f32_16x16x32_bf16 v[128:131], v[24:27], v[76:79], v[128:131]
    v_mfma_f32_16x16x32_bf16 v[132:135], v[28:31], v[76:79], v[132:135]
    v_mfma_f32_16x16x32_bf16 v[144:147], v[16:19], v[104:107], v[144:147]
    v_mfma_f32_16x16x32_bf16 v[148:151], v[20:23], v[104:107], v[148:151]
    v_pk_mul_f32 v[120:121], v[120:121], s[56:57]
    v_pk_mul_f32 v[122:123], v[122:123], s[56:57]
    v_pk_mul_f32 v[124:125], v[124:125], s[56:57]
    v_pk_mul_f32 v[126:127], v[126:127], s[56:57]
    v_cvt_pk_bf16_f32 v52, v120, v121
    v_cvt_pk_bf16_f32 v53, v122, v123
    v_cvt_pk_bf16_f32 v54, v124, v125
    v_cvt_pk_bf16_f32 v55, v126, v127
    ds_write_b128 v7, v[52:55] offset:24576
    v_mfma_f32_16x16x32_bf16 v[136:139], v[24:27], v[92:95], v[136:139]
    v_mfma_f32_16x16x32_bf16 v[140:143], v[28:31], v[92:95], v[140:143]
    v_pk_mul_f32 v[128:129], v[128:129], s[56:57]
    v_pk_mul_f32 v[130:131], v[130:131], s[56:57]
    v_pk_mul_f32 v[132:133], v[132:133], s[56:57]
    v_pk_mul_f32 v[134:135], v[134:135], s[56:57]
    v_cvt_pk_bf16_f32 v68, v128, v129
    v_cvt_pk_bf16_f32 v69, v130, v131
    v_cvt_pk_bf16_f32 v70, v132, v133
    v_cvt_pk_bf16_f32 v71, v134, v135
    ds_write_b128 v7, v[68:71] offset:28672
    v_mfma_f32_16x16x32_bf16 v[144:147], v[24:27], v[108:111], v[144:147]
    v_mfma_f32_16x16x32_bf16 v[148:151], v[28:31], v[108:111], v[148:151]
    v_pk_mul_f32 v[136:137], v[136:137], s[56:57]
    v_pk_mul_f32 v[138:139], v[138:139], s[56:57]
    v_pk_mul_f32 v[140:141], v[140:141], s[56:57]
    v_pk_mul_f32 v[142:143], v[142:143], s[56:57]
    v_cvt_pk_bf16_f32 v84, v136, v137
    v_cvt_pk_bf16_f32 v85, v138, v139
    v_cvt_pk_bf16_f32 v86, v140, v141
    v_cvt_pk_bf16_f32 v87, v142, v143
    ds_write_b128 v7, v[84:87] offset:32768
    v_pk_mul_f32 v[144:145], v[144:145], s[56:57]
    v_pk_mul_f32 v[146:147], v[146:147], s[56:57]
    v_pk_mul_f32 v[148:149], v[148:149], s[56:57]
    v_pk_mul_f32 v[150:151], v[150:151], s[56:57]
    v_cvt_pk_bf16_f32 v100, v144, v145
    v_cvt_pk_bf16_f32 v101, v146, v147
    v_cvt_pk_bf16_f32 v102, v148, v149
    v_cvt_pk_bf16_f32 v103, v150, v151
    ds_write_b128 v7, v[100:103] offset:36864
    s_waitcnt lgkmcnt(0)
    s_barrier
    ds_read_b128 v[32:35], v8
    ds_read_b128 v[36:39], v8 offset:8192
    ds_read_b128 v[40:43], v8 offset:16384
    s_waitcnt lgkmcnt(2)
    buffer_store_dwordx4 v[32:35], v6, s[32:35], s47 offen sc1
    s_waitcnt lgkmcnt(1)
    buffer_store_dwordx4 v[36:39], v6, s[32:35], s48 offen sc1
    s_waitcnt lgkmcnt(0)
    buffer_store_dwordx4 v[40:43], v6, s[32:35], s49 offen sc1
    s_endpgm
.K1_W:
    s_lshl_b32 s43, s3, 12
    s_mov_b32 m0, s43
    s_sub_u32 s40, s2, 125
    s_lshl_b32 s41, s40, 15
    s_add_u32 s41, s41, s43
    s_mov_b32 s42, s41
    v_lshlrev_b32 v12, 4, v2
    s_waitcnt lgkmcnt(0)
    s_add_u32 s28, s20, 9437184
    s_addc_u32 s29, s21, 0
    s_and_b32 s29, s29, 0xffff
    s_mov_b32 s30, 110592
    s_mov_b32 s31, 0x00020000
    s_mov_b32 s24, s18
    s_and_b32 s25, s19, 0xffff
    s_mov_b32 s26, 65536
    s_mov_b32 s27, 0x00020000
    s_cmp_lg_u32 s40, 2
    s_cbranch_scc1 .K1_w1
    s_mov_b32 s41, s43
    s_add_u32 s42, s43, 77824
    s_mov_b32 s24, s14
    s_and_b32 s25, s15, 0xffff
    s_mov_b32 s26, 65536
    s_mov_b32 s27, 0x00020000
.K1_w1:
    buffer_load_dwordx4 v5, s[24:27], s41 offen offset:0 lds
    buffer_load_dwordx4 v5, s[24:27], s41 offen offset:1024 lds
    buffer_load_dwordx4 v5, s[24:27], s41 offen offset:2048 lds
    buffer_load_dwordx4 v5, s[24:27], s41 offen offset:3072 lds
    v_bfe_u32 v9, v2, 2, 2
    v_lshl_add_u32 v10, v3, 3, v9
    v_add_u32 v11, 4, v10
    v_lshrrev_b32 v13, 1, v9
    v_lshl_add_u32 v13, v3, 2, v13
    v_and_b32 v14, 1, v9
    v_lshl_add_u32 v13, v14, 4, v13
    v_add_u32 v14, 2, v13
    s_cmp_lg_u32 s40, 1
    s_cselect_b64 vcc, -1, 0
    v_cndmask_b32 v10, v13, v10, vcc
    v_cndmask_b32 v11, v14, v11, vcc
    v_and_b32 v13, 3, v2
    v_lshlrev_b32 v13, 3, v13
    s_lshl_b32 s44, s3, 5
    v_or_b32 v13, s44, v13
    v_and_b32 v14, 3, v10
    v_lshlrev_b32 v14, 6, v14
    v_xor_b32 v14, v14, v13
    v_lshl_or_b32 v10, v10, 8, v14
    v_and_b32 v14, 3, v11
    v_lshlrev_b32 v14, 6, v14
    v_xor_b32 v14, v14, v13
    v_lshl_or_b32 v11, v11, 8, v14
    s_waitcnt vmcnt(0)
    s_barrier
    ds_read_b64_tr_b16 v[32:33], v10 offset:0
    ds_read_b64_tr_b16 v[34:35], v11 offset:0
    ds_read_b64_tr_b16 v[36:37], v10 offset:8192
    ds_read_b64_tr_b16 v[38:39], v11 offset:8192
    ds_read_b64_tr_b16 v[40:41], v10 offset:16384
    ds_read_b64_tr_b16 v[42:43], v11 offset:16384
    ds_read_b64_tr_b16 v[44:45], v10 offset:24576
    ds_read_b64_tr_b16 v[46:47], v11 offset:24576
    s_waitcnt lgkmcnt(0)
    buffer_store_dwordx4 v[32:35], v12, s[28:31], s42 offen offset:0 sc1
    buffer_store_dwordx4 v[36:39], v12, s[28:31], s42 offen offset:1024 sc1
    buffer_store_dwordx4 v[40:43], v12, s[28:31], s42 offen offset:2048 sc1
    buffer_store_dwordx4 v[44:47], v12, s[28:31], s42 offen offset:3072 sc1
    s_endpgm
.K1_M:
    s_waitcnt lgkmcnt(0)
    s_add_u32 s28, s20, 9437184
    s_addc_u32 s29, s21, 0
    s_and_b32 s29, s29, 0xffff
    s_mov_b32 s30, 110592
    s_mov_b32 s31, 0x00020000
    s_mov_b32 s24, s14
    s_and_b32 s25, s15, 0xffff
    s_mov_b32 s26, 66048
    s_mov_b32 s27, 0x00020000
    s_mov_b32 s32, s16
    s_and_b32 s33, s17, 0xffff
    s_mov_b32 s34, 256
    s_mov_b32 s35, 0x00020000
    s_add_u32 s36, s20, 1024
    s_addc_u32 s37, s21, 0
    s_and_b32 s37, s37, 0xffff
    s_mov_b32 s38, 256
    s_mov_b32 s39, 0x00020000
    s_lshl_b32 s44, s3, 5
    s_add_u32 s44, s44, 65536
    v_lshlrev_b32 v6, 1, v4
    buffer_load_ushort v16, v6, s[24:27], s44 offen
    buffer_load_ushort v17, v6, s[24:27], s44 offen offset:256
    s_lshl_b32 s45, s3, 6
    v_lshlrev_b32 v7, 3, v3
    buffer_load_dwordx2 v[18:19], v7, s[32:35], s45 offen
    buffer_load_dwordx2 v[20:21], v7, s[32:35], s45 offen offset:32
    v_mov_b32 v14, 0
    v_lshlrev_b32 v13, 2, v0
    buffer_store_dword v14, v13, s[36:39], 0 offen sc1
    v_and_b32 v8, 1, v2
    v_lshlrev_b32 v8, 4, v8
    v_mov_b32 v9, 0x3f80
    v_lshlrev_b32 v8, v8, v9
    v_lshrrev_b32 v9, 1, v4
    v_lshlrev_b32 v10, 2, v3
    v_sub_u32 v9, v9, v10
    v_cmp_eq_u32 vcc, 0, v9
    s_nop 1
    v_cndmask_b32 v24, 0, v8, vcc
    v_cmp_eq_u32 vcc, 1, v9
    s_nop 1
    v_cndmask_b32 v25, 0, v8, vcc
    v_cmp_eq_u32 vcc, 2, v9
    s_nop 1
    v_cndmask_b32 v26, 0, v8, vcc
    v_cmp_eq_u32 vcc, 3, v9
    s_nop 1
    v_cndmask_b32 v27, 0, v8, vcc
    s_mov_b32 s46, 3216550459
    s_mov_b32 s47, 0x05040100
    s_mov_b32 s48, 0x07060302
    v_cmp_eq_u32 s[50:51], 2, v3
    v_cmp_eq_u32 s[52:53], 3, v3
    s_and_b32 s44, s3, 1
    s_lshl_b32 s44, s44, 9
    s_lshl_b32 s45, s3, 9
    s_add_u32 s45, s45, 512
    v_mov_b32 v12, s44
    v_mov_b32 v13, s45
    v_cmp_gt_u32 vcc, 32, v2
    s_nop 1
    v_cndmask_b32 v12, v13, v12, vcc
    v_lshl_add_u32 v12, v2, 4, v12
    s_waitcnt vmcnt(1)
    v_lshlrev_b32 v16, 16, v16
    v_lshlrev_b32 v17, 16, v17
    v_mul_f32 v10, s46, v16
    v_mul_f32 v17, s46, v17
    v_cvt_pk_bf16_f32 v11, 0, v10
    v_cvt_pk_bf16_f32 v17, 0, v17
    v_fma_f32 v10, s46, v16, -v11
    v_cvt_pk_bf16_f32 v10, 0, v10
    v_cndmask_b32 v27, v27, v11, s[50:51]
    v_cndmask_b32 v25, v25, v17, s[52:53]
    v_cndmask_b32 v27, v27, v10, s[52:53]
    v_lshlrev_b32 v13, 4, v0
    s_mov_b32 s44, 69632
    buffer_store_dwordx4 v[24:27], v12, s[28:31], s44 offen sc1
    v_perm_b32 v28, v20, v18, s47
    v_perm_b32 v29, v20, v18, s48
    v_perm_b32 v30, v21, v19, s47
    v_perm_b32 v31, v21, v19, s48
    s_cmp_ge_u32 s3, 4
    s_cbranch_scc1 .K1_end
    s_mov_b32 s44, 65536
    buffer_store_dwordx4 v[28:31], v13, s[28:31], s44 offen sc1
.K1_end:
    s_endpgm

.globl egnn_main_kernel
.p2align 8
.type egnn_main_kernel,@function
egnn_main_kernel:
    s_cmp_ge_u32 s2, 256
    s_cbranch_scc1 .K2_end
    s_mov_b32 s64, 0
    s_mov_b32 s65, 32
    s_mov_b32 s66, 0
.K2_again:
    s_setprio 1
    s_load_dwordx2 s[24:25], s[0:1], 80
    s_load_dwordx2 s[48:49], s[0:1], 8
    s_load_dwordx2 s[36:37], s[0:1], 0
    s_load_dwordx2 s[40:41], s[0:1], 80
    v_lshrrev_b32 v2, 6, v0
    s_and_b32 s73, s2, 7
    v_and_b32 v1, 63, v0
    s_lshl_b32 s73, s73, 5
    v_readfirstlane_b32 s3, v2
    s_lshr_b32 s67, s2, 3
    v_lshrrev_b32 v27, 3, v0
    s_add_u32 s67, s67, s73
    v_lshlrev_b32 v3, 4, v27
    s_lshr_b32 s73, s67, 2
    s_mul_i32 s73, s73, 2032
    s_lshl2_add_u32 s73, s67, s73
    s_add_u32 s73, s73, 10485760
    v_lshlrev_b32 v5, 4, v1
    s_mov_b32 s26, 10616832
    s_mov_b32 s27, 0x00020000
    v_lshlrev_b32 v34, 4, v1
    s_mul_i32 s60, s67, 625
    s_add_u32 s61, s60, 640
    s_add_u32 s60, s60, 15
    s_lshr_b32 s60, s60, 4
    s_lshr_b32 s61, s61, 4
    s_sub_u32 s61, s61, s60
    s_mov_b32 s50, 60000
    s_mov_b32 s51, 0x00020000
    s_bfm_b64 s[92:93], s61, 1
    s_lshl_b32 s28, s3, 12
    s_bitcmp1_b32 s2, 3
    s_cselect_b32 s75, 2048, 0
    s_or_b32 s28, s28, s75
    v_lshlrev_b32 v20, 4, v0
    v_mov_b64 v[16:17], 0
    v_mov_b64 v[18:19], 0
    ds_write_b64 v20, v[16:17]
    s_cmp_ge_u32 s3, 8
    s_cbranch_scc1 .K2_i0
    ds_write_b128 v20, v[16:19] offset:16384
.K2_i0:
    s_cmp_eq_u32 s3, 15
    s_cbranch_scc0 .K2_n15
    s_setprio 3
    v_mov_b64 v[36:37], 0
    v_mov_b32 v38, 0
    v_mad_i32_i24 v111, v1, 6, -6
    s_mul_i32 s76, s60, 6
    s_mov_b32 s77, 9506816
    s_mov_b32 s78, 9507840
    s_mov_b32 m0, 114944
    s_waitcnt lgkmcnt(0)
    v_mov_b32 v32, 0
    s_mov_b32 exec_hi, 0xff
    buffer_load_dword v32, v3, s[24:27], s73 offen
    s_mov_b64 exec, s[92:93]
    buffer_load_short_d16_hi v36, v111, s[48:51], s76 offen
    buffer_load_short_d16_hi v37, v111, s[48:51], s76 offen offset:2
    buffer_load_short_d16_hi v38, v111, s[48:51], s76 offen offset:4
    s_mov_b64 exec, -1
    buffer_load_dwordx4 v5, s[24:27], s77 offen lds
    s_mov_b32 m0, 110848
    s_nop 0
    buffer_load_dwordx4 v5, s[24:27], s78 offen offset:0 lds
    buffer_load_dwordx4 v5, s[24:27], s78 offen offset:1024 lds
    buffer_load_dwordx4 v5, s[24:27], s78 offen offset:2048 lds
    buffer_load_dwordx4 v5, s[24:27], s78 offen offset:3072 lds
    s_barrier
    v_mul_u32_u24 v111, 43, v1
    v_lshrrev_b32 v111, 7, v111
    v_mad_i32_i24 v111, v111, -3, v1
    v_mov_b32 v39, 0x0c0c0c0c
    v_mov_b32 v35, 0x07060100
    v_mov_b32 v108, 0x0c0c0504
    v_mov_b32 v109, 0x01000c0c
    v_mov_b32 v110, 0x07060c0c
    v_cmp_eq_u32 s[80:81], 1, v111
    v_cmp_eq_u32 s[82:83], 2, v111
    v_cmp_ne_u32 s[84:85], 0, v111
    v_cndmask_b32 v35, v39, v35, s[92:93]
    v_cndmask_b32 v39, v39, v108, s[80:81]
    v_cndmask_b32 v35, v35, v110, s[84:85]
    v_cndmask_b32 v39, v39, v109, s[82:83]
    v_and_b32 v26, 7, v0
    s_add_u32 s70, s64, s65
    v_mul_u32_u24 v4, 20480, v27
    s_mov_b32 s71, 5242880
    v_lshl_add_u32 v28, v26, 1, s64
    s_xor_b32 s29, s28, 2048
    v_lshl_add_u32 v4, v28, 3, v4
    v_cmp_gt_u32 vcc, 32, v1
    s_and_b32 s62, s3, 3
    v_mov_b32 v6, 0x3f80
    s_lshl_b32 s63, s62, 6
    v_mov_b32 v85, 0
    s_lshl_b32 s54, s3, 11
    v_cndmask_b32 v84, 0, v6, vcc
    s_add_u32 s54, s54, 109824
    v_mov_b64 v[86:87], 0
    s_lshl_b32 s75, s3, 10
    v_and_b32 v6, 32, v1
    s_sub_u32 s67, s75, 4096
    v_lshlrev_b32 v104, 4, v6
    s_lshl_b32 s30, s60, 8
    v_lshlrev_b32 v105, 4, v6
    s_add_u32 s30, s30, s67
    s_setprio 2
    s_waitcnt vmcnt(8)
    s_branch .K2_tabd
.K2_n15:
    s_waitcnt lgkmcnt(0)
    buffer_load_dword v32, v3, s[24:27], s73 offen
    s_getpc_b64 s[32:33]
.K2_pc:
    s_bfe_u32 s34, s2, 0x30003
    s_mul_i32 s34, s34, 15
    s_add_u32 s34, s34, s3
    s_lshl_b32 s34, s34, 7
    s_min_u32 s34, s34, .K2_end-.K2_pc
    s_load_dword s35, s[32:33], s34
    v_and_b32 v26, 7, v0
    s_add_u32 s70, s64, s65
    v_mul_u32_u24 v4, 20480, v27
    s_mov_b32 s71, 5242880
    v_lshl_add_u32 v28, v26, 1, s64
    s_xor_b32 s29, s28, 2048
    v_lshl_add_u32 v4, v28, 3, v4
    v_cmp_gt_u32 vcc, 32, v1
    s_barrier
    s_add_u32 m0, s28, 49408
    s_nop 0
    buffer_load_dwordx4 v34, s[48:51], s28 offen offset:0 lds
    s_and_b32 s62, s3, 3
    v_mov_b32 v6, 0x3f80
    s_lshl_b32 s63, s62, 6
    v_mov_b32 v85, 0
    s_lshl_b32 s54, s3, 11
    v_cndmask_b32 v84, 0, v6, vcc
    s_add_u32 s54, s54, 109824
    v_mov_b64 v[86:87], 0
    buffer_load_dwordx4 v34, s[48:51], s28 offen offset:1024 lds
    s_lshl_b32 s75, s3, 10
    v_and_b32 v6, 32, v1
    s_sub_u32 s67, s75, 4096
    v_lshlrev_b32 v104, 4, v6
    s_lshl_b32 s30, s60, 8
    v_lshlrev_b32 v105, 4, v6
    s_add_u32 s30, s30, s67
    s_setprio 2
    s_waitcnt vmcnt(2)
.K2_g1:
.K2_tabd:
    v_min_u32_sdwa v29, s70, v32 dst_sel:DWORD dst_unused:UNUSED_PAD src0_sel:DWORD src1_sel:WORD_1
    v_add_u32_sdwa v4, v4, v32 dst_sel:DWORD dst_unused:UNUSED_PAD src0_sel:DWORD src1_sel:WORD_0
    v_sub_u32 v29, v29, v28
    v_cmp_lt_i32 s[76:77], 0, v29
    v_cmp_lt_i32 s[80:81], 16, v29
    s_mov_b64 exec, s[76:77]
    s_cbranch_execz .K2_ldd
    buffer_load_dwordx4 v[8:11], v4, s[24:27], s71 offen
    s_mov_b64 exec, s[80:81]
    s_cbranch_execz .K2_ldd
    buffer_load_dwordx4 v[12:15], v4, s[24:27], s71 offen offset:128
.K2_ldd:
    s_mov_b64 exec, -1
    s_setprio 0
    v_and_b32 v24, 48, v5
    s_add_u32 s31, s67, 153600
    v_or_b32 v97, s63, v24
    s_mov_b32 s38, 2560000
    v_xor_b32 v99, 32, v97
    s_mov_b32 s39, 0x00020000
    v_and_b32 v7, 16, v1
    v_and_b32 v25, 12, v1
    v_lshrrev_b32 v30, 4, v1
    v_lshl_or_b32 v33, s62, 2, v30
    v_xor_b32 v33, v33, v1
    v_and_b32 v33, 15, v33
    v_lshlrev_b32 v33, 4, v33
    v_lshl_or_b32 v33, v30, 8, v33
    v_lshlrev_b32 v25, 2, v25
    s_movk_i32 s42, 10132
    v_lshl_or_b32 v25, v7, 4, v25
    s_mov_b32 s43, 0x00020000
    v_lshl_or_b32 v102, v6, 1, v25
    s_movk_i32 s72, 1024
    v_and_b32 v6, 8, v1
    s_movk_i32 s52, 512
    v_mul_u32_u24 v6, 132, v6
    s_movk_i32 s53, 512
    v_lshl_or_b32 v6, v24, 2, v6
    s_mov_b32 s58, 0
    v_and_b32 v25, 4, v1
    s_mov_b32 s59, 0xffff
    v_lshl_or_b32 v6, v25, 7, v6
    v_add3_u32 v6, v6, v7, s54
    v_and_b32 v2, 15, v1
    v_mul_u32_u24 v25, 1536, v7
    s_lshl_b32 s75, s62, 10
    v_lshl_add_u32 v25, v2, 4, v25
    s_add_u32 s75, s75, 110336
    v_cndmask_b32 v100, v25, v6, vcc
    v_xor_b32 v6, 32, v6
    v_cndmask_b32 v101, v25, v6, vcc
    v_and_b32 v25, 2, v1
    v_mul_u32_u24 v25, 12288, v25
    v_and_b32 v6, 60, v1
    v_lshl_add_u32 v25, v6, 2, v25
    v_and_b32 v6, 1, v1
    v_lshl_add_u32 v103, v6, 3, v25
    v_mov_b32 v25, s75
    v_mov_b32 v6, 114944
    v_cndmask_b32 v25, v25, v6, vcc
    v_add_u32 v107, v25, v5
    s_add_u32 s75, s63, 142720
    v_lshl_add_u32 v106, v2, 1, s75
    s_or_b32 s41, s41, 16777216
    s_cmp_lt_u32 s3, 4
    s_cbranch_scc1 .K2_p0
    v_add_u32 v120, s67, v5
    s_add_u32 s67, s67, 12288
    v_mov_b64 v[40:41], 0
    s_mov_b32 s96, 0x0000bf80
    v_mov_b64 v[42:43], 0
    s_mov_b32 s97, 0xbf800000
    v_mov_b64 v[44:45], 0
    s_movk_i32 s98, 0x3f80
    v_mov_b64 v[46:47], 0
    s_mov_b32 s99, 49408
    v_mov_b64 v[48:49], 0
    s_movk_i32 s22, 72
    v_mov_b64 v[50:51], 0
    s_cmp_ge_u32 s3, 8
    v_mov_b64 v[52:53], 0
    s_cmovk_i32 s22, 144
    v_mov_b64 v[54:55], 0
    s_cmp_ge_u32 s3, 12
    s_cmovk_i32 s22, 144
    s_branch .K2_f2
.K2_p0:
    v_xor_b32 v3, v2, v30
    v_lshlrev_b32 v3, 4, v3
    v_lshl_or_b32 v3, v2, 8, v3
    v_add_u32 v124, 153600, v3
    v_xor_b32 v125, 64, v124
    v_xor_b32 v126, 128, v124
    v_xor_b32 v127, 192, v124
    s_add_u32 s73, s63, 142720
    v_mul_u32_u24 v3, 272, v2
    v_lshl_add_u32 v3, v30, 3, v3
    v_add_u32 v2, s73, v3
    s_movk_i32 s22, 72
    s_lshl_b32 s84, s3, 13
    s_add_u32 s84, s84, 9515008
    s_add_u32 s85, s84, 4096
.K2_f2:
    s_pack_ll_b32_b16 s70, s59, s70
    v_cmp_lt_i32 s[78:79], 1, v29
    v_cmp_lt_i32 s[82:83], 17, v29
    v_cmp_lt_u32 s[86:87], s70, v32
    s_lshr_b32 s73, s3, 2
    v_mov_b64 v[72:73], 0
    s_mul_i32 s55, s73, -1056
    v_mov_b64 v[74:75], 0
    s_add_u32 s55, s55, 44352
    v_mov_b32 v7, 16
    s_cmp_eq_u32 s73, 3
    v_mov_b32 v6, 23804
    s_cselect_b32 s55, 0, s55
    v_lshlrev_b32 v4, 2, v1
    s_lshl_b32 s56, s62, 8
    v_mov_b64 v[88:89], 0
    s_add_u32 s55, s55, s56
    v_mov_b64 v[90:91], 0
    s_add_u32 s56, s56, 1056
    v_mov_b64 v[92:93], 0
    s_mov_b32 s57, 0
    v_mov_b64 v[94:95], 0
    s_movk_i32 s75, 256
    s_setprio 2
    s_cmp_lg_u32 s3, 15
    s_cbranch_scc1 .K2_rw
    s_waitcnt vmcnt(0)
    ds_write_b128 v5, v[36:39] offset:48128
    ds_write_b32 v4, v35 offset:49152
.K2_rw:
    s_waitcnt vmcnt(0)
.K2_g2:
.K2_cnt:
    s_mov_b64 exec, s[76:77]
    v_bfe_u32 v16, v9, 8, 8
    ds_add_rtn_u32 v20, v16, v7 offset:23552
    s_mov_b64 exec, s[78:79]
    v_bfe_u32 v17, v11, 8, 8
    ds_add_rtn_u32 v21, v17, v7 offset:23552
    s_or_b64 exec, s[80:81], s[86:87]
    s_cbranch_scc0 .K2_cntd
    s_mov_b64 exec, s[80:81]
    v_bfe_u32 v18, v13, 8, 8
    ds_add_rtn_u32 v22, v18, v7 offset:23552
    s_mov_b64 exec, s[82:83]
    v_bfe_u32 v19, v15, 8, 8
    ds_add_rtn_u32 v23, v19, v7 offset:23552
    s_mov_b64 exec, s[86:87]
    ds_write_b32 v6, v7
.K2_cntd:
    s_mov_b64 exec, -1
    s_bitcmp1_b32 32767, s3
    s_cbranch_scc0 .K2_g3
    s_add_u32 m0, s29, 49408
    s_nop 0
    buffer_load_dwordx4 v34, s[48:51], s29 offen offset:0 lds
.K2_g3:
    s_bitcmp1_b32 16368, s3
    s_cbranch_scc0 .K2_g4
    s_mov_b32 m0, s31
    s_nop 0
    buffer_load_dwordx4 v33, s[36:39], s30 offen nt lds
.K2_g4:
    s_waitcnt lgkmcnt(0)
    s_barrier
    ds_read_b32 v30, v4 offset:23552
    s_bitcmp1_b32 32767, s3
    s_cbranch_scc0 .K2_g5
    s_add_u32 m0, s29, 49408
    s_nop 0
    buffer_load_dwordx4 v34, s[48:51], s29 offen offset:1024 lds
.K2_g5:
    s_waitcnt lgkmcnt(0)
    ds_read_b128 v[76:79], v107
    ds_read_b128 v[80:83], v107 offset:512
    v_max_u32 v4, s75, v30
    v_readlane_b32 s71, v30, 63
    v_cndmask_b32 v4, 0, v4, s[92:93]
    v_mov_b32 v5, v4
    s_nop 1
    v_add_u32_dpp v5, v5, v5 row_shr:1 row_mask:0xf bank_mask:0xf
    s_nop 1
    v_add_u32_dpp v5, v5, v5 row_shr:2 row_mask:0xf bank_mask:0xf
    s_nop 1
    v_add_u32_dpp v5, v5, v5 row_shr:4 row_mask:0xf bank_mask:0xf
    s_nop 1
    v_add_u32_dpp v5, v5, v5 row_shr:8 row_mask:0xf bank_mask:0xf
    s_nop 1
    v_add_u32_dpp v5, v5, v5 row_bcast:15 row_mask:0xa bank_mask:0xf
    s_nop 1
    v_add_u32_dpp v5, v5, v5 row_bcast:31 row_mask:0xc bank_mask:0xf
    v_sub_u32 v4, v5, v4
    v_readlane_b32 s70, v5, 63
    ds_bpermute_b32 v24, v16, v4
    ds_bpermute_b32 v25, v17, v4
    v_readlane_b32 s68, v5, 16
    s_cmp_le_u32 s70, 23552
    s_cbranch_scc0 .K2_over
    s_cmp_eq_u64 s[80:81], 0
    s_cbranch_scc1 .K2_bpd
    ds_bpermute_b32 v26, v18, v4
    ds_bpermute_b32 v27, v19, v4
    s_mov_b64 exec, s[80:81]
    s_waitcnt lgkmcnt(0)
    v_add_u32 v26, v26, v22
    v_add_u32 v27, v27, v23
    ds_write_b64 v26, v[12:13]
    s_mov_b64 exec, s[82:83]
    ds_write_b64 v27, v[14:15]
    s_mov_b64 exec, -1
.K2_bpd:
    s_add_u32 s73, s70, 511
    s_lshr_b32 s69, s73, 9
    s_sub_u32 s68, s68, 1
    s_lshr_b32 s68, s68, 9
    s_cmp_lt_u32 s3, 8
    s_cselect_b32 s69, s69, s68
    s_cselect_b32 s68, s68, 0
    s_mov_b64 exec, s[76:77]
    s_waitcnt lgkmcnt(0)
    v_add_u32 v24, v24, v20
    v_add_u32 v25, v25, v21
    ds_write_b64 v24, v[8:9]
    s_mov_b64 exec, s[78:79]
    ds_write_b64 v25, v[10:11]
    s_mov_b64 exec, -1
    s_setprio 1
    s_bitcmp1_b32 15, s3
    s_cbranch_scc0 .K2_g6
    buffer_load_dwordx4 v[56:59], v34, s[24:27], s84 offen offset:0
    buffer_load_dwordx4 v[108:111], v34, s[24:27], s85 offen offset:0
    buffer_load_dwordx4 v[60:63], v34, s[24:27], s84 offen offset:1024
    buffer_load_dwordx4 v[112:115], v34, s[24:27], s85 offen offset:1024
    buffer_load_dwordx4 v[64:67], v34, s[24:27], s84 offen offset:2048
    buffer_load_dwordx4 v[116:119], v34, s[24:27], s85 offen offset:2048
    buffer_load_dwordx4 v[68:71], v34, s[24:27], s84 offen offset:3072
    buffer_load_dwordx4 v[120:123], v34, s[24:27], s85 offen offset:3072
.K2_g6:
    s_mov_b32 m0, s54
    s_add_u32 s73, s68, s69
    s_lshr_b32 s73, s73, 1
    s_bitcmp1_b32 s3, 2
    s_cselect_b32 s69, s73, s69
    s_cselect_b32 s68, s68, s73
    s_lshl_b32 s74, s68, 9
    v_add_u32 v102, s74, v102
    v_add_u32 v5, 511, v5
    v_add_u32 v4, 511, v4
    v_lshrrev_b32 v5, 9, v5
    v_lshrrev_b32 v4, 9, v4
    s_sub_u32 s74, s74, s52
    v_cmp_eq_u32 vcc, v4, v5
    v_cmp_ge_u32 s[76:77], s68, v5
    v_lshlrev_b32 v5, 2, v5
    v_mov_b32 v4, 252
    s_and_b64 vcc, vcc, s[92:93]
    s_lshr_b64 s[78:79], vcc, 1
    s_andn2_b64 s[78:79], s[92:93], s[78:79]
    v_cndmask_b32 v3, v4, v5, s[78:79]
    v_cndmask_b32 v5, v7, v6, vcc
    ds_permute_b32 v3, v3, v5
    s_bitcmp1_b32 15, s3
    s_waitcnt vmcnt(8)
    s_cbranch_scc1 .K2_g7
    s_waitcnt vmcnt(0)
.K2_g7:
    s_cmp_lt_u32 s3, 4
    s_waitcnt lgkmcnt(1)
    s_barrier
    ds_read_u16 v96, v102 offset:6
    ds_read_u16 v98, v102 offset:134
    s_cbranch_scc1 .K2_lo
    ds_read_b64 v[8:9], v120
    ds_read_b64 v[10:11], v120 offset:12288
    s_waitcnt lgkmcnt(1)
    v_bfe_u32 v24, v9, 8, 8
    v_add_u32_sdwa v12, s99, v8 dst_sel:DWORD dst_unused:UNUSED_PAD src0_sel:DWORD src1_sel:WORD_0
    v_lshlrev_b32 v16, 2, v24
    ds_read_b32 v24, v24 offset:49152
    ds_read_b128 v[16:19], v16 offset:48128
    ds_read2_b32 v[12:13], v12 offset0:0 offset1:1
    s_waitcnt lgkmcnt(15)
    buffer_load_dwordx4 v[96:97], s[40:43], s72 idxen offen lds
    buffer_load_dwordx4 v[98:99], s[40:43], 0 idxen offen offset:1024 lds
    s_setprio 0
    ds_read_u16 v96, v102 offset:518
    ds_read_u16 v98, v102 offset:646
    s_cmp_ge_u32 s67, s70
    s_cbranch_scc1 .K2_o1
    s_waitcnt lgkmcnt(5)
    v_bfe_u32 v25, v11, 8, 8
    v_add_u32_sdwa v14, s99, v10 dst_sel:DWORD dst_unused:UNUSED_PAD src0_sel:DWORD src1_sel:WORD_0
    v_lshlrev_b32 v20, 2, v25
    ds_read_b32 v25, v25 offset:49152
    ds_read_b128 v[20:23], v20 offset:48128
    ds_read2_b32 v[14:15], v14 offset0:0 offset1:1
.K2_o1:
    v_cmp_ne_u32 s[88:89], 0, v3
    v_cmp_eq_u32 s[90:91], v6, v3
    v_add_u32 v103, s74, v103
    v_mad_u32_u24 v100, v104, s68, v100
    v_mad_u32_u24 v101, v104, s68, v101
    s_and_b64 s[76:77], s[76:77], s[92:93]
    s_bcnt1_i32_b64 s73, s[76:77]
    s_lshl_b64 s[76:77], -2, s68
    s_and_b64 s[88:89], s[88:89], s[76:77]
    s_orn2_b64 s[84:85], s[90:91], s[88:89]
    s_mov_b64 s[86:87], s[84:85]
    s_ff1_i32_b64 s74, s[88:89]
    s_bitset1_b64 s[86:87], s74
    s_or_b32 s74, s66, s71
    s_cselect_b64 s[86:87], -1, s[86:87]
    s_or_b32 s77, s22, 5
    s_brev_b32 s77, s77
    s_mov_b32 s76, 0
    s_sub_u32 s74, 63, s69
    s_lshr_b64 s[76:77], s[76:77], s74
    s_or_b64 s[84:85], s[84:85], s[76:77]
    s_add_u32 s74, s68, 1
    s_bitset1_b64 s[84:85], s74
    s_mul_i32 s74, s73, 1056
    s_add_u32 s56, s56, s74
    s_mul_i32 s74, s73, 43
    s_lshr_b32 s74, s74, 7
    s_mul_i32 s76, s74, 816
    s_mul_i32 s74, s74, 3
    s_sub_u32 s83, s73, s74
    v_add_u32 v106, s76, v106
    s_cmp_gt_u32 s83, 0
    s_cselect_b32 s76, 816, 0
    s_cmp_gt_u32 s83, 1
    s_cselect_b32 s77, 816, 0
    v_add_u32 v6, s76, v106
    v_add_u32 v7, s77, v106
    s_waitcnt lgkmcnt(0)
    v_alignbit_b32 v12, v13, v12, v9
    v_lshrrev_b32_sdwa v13, v9, v13 dst_sel:WORD_1 dst_unused:UNUSED_PAD src0_sel:DWORD src1_sel:DWORD
    v_dot2c_f32_bf16 v16, s96, v12
    v_dot2c_f32_bf16 v17, s97, v12
    v_sub_f32 v18, v18, v13
    v_perm_b32 v29, v9, s98, v24
    v_mul_f32 v12, v18, v18
    v_cvt_pk_bf16_f32 v18, v18, v18
    v_fmac_f32 v12, v16, v16
    v_perm_b32 v34, v18, v18, v19
    v_fmac_f32 v12, v17, v17
    v_cvt_pk_bf16_f32 v17, v17, v17
    v_cvt_pk_bf16_f32 v16, v16, v12
    v_perm_b32 v32, v17, v17, v19
    v_perm_b32 v33, v8, v17, v24
    v_perm_b32 v35, v16, v18, v24
    ds_write_b128 v120, v[32:35] offset:24576
    v_perm_b32 v28, s98, v16, v19
    v_perm_b32 v30, v16, s98, v19
    v_perm_b32 v31, v16, v16, v24
    ds_write_b128 v120, v[28:31] offset:0
    s_cmp_ge_u32 s67, s70
    s_cbranch_scc1 .K2_bd
    v_alignbit_b32 v14, v15, v14, v11
    v_lshrrev_b32_sdwa v15, v11, v15 dst_sel:WORD_1 dst_unused:UNUSED_PAD src0_sel:DWORD src1_sel:DWORD
    v_dot2c_f32_bf16 v20, s96, v14
    v_dot2c_f32_bf16 v21, s97, v14
    v_sub_f32 v22, v22, v15
    v_perm_b32 v109, v11, s98, v25
    v_mul_f32 v14, v22, v22
    v_cvt_pk_bf16_f32 v22, v22, v22
    v_fmac_f32 v14, v20, v20
    v_perm_b32 v114, v22, v22, v23
    v_fmac_f32 v14, v21, v21
    v_cvt_pk_bf16_f32 v21, v21, v21
    v_cvt_pk_bf16_f32 v20, v20, v14
    v_perm_b32 v112, v21, v21, v23
    v_perm_b32 v113, v10, v21, v25
    v_perm_b32 v115, v20, v22, v25
    ds_write_b128 v120, v[112:115] offset:36864
    v_perm_b32 v108, s98, v20, v23
    v_perm_b32 v110, v20, s98, v23
    v_perm_b32 v111, v20, v20, v25
    ds_write_b128 v120, v[108:111] offset:12288
.K2_bd:
    s_waitcnt lgkmcnt(0)
    s_barrier
    s_mov_b64 exec, s[58:59]
    ds_read_u16 v76, v6 offset:0
    ds_read_u16 v80, v6 offset:32
    ds_read_u16_d16_hi v78, v7 offset:272
    ds_read_u16_d16_hi v82, v7 offset:304
    ds_read_u16 v77, v106 offset:544
    ds_read_u16 v81, v106 offset:576
    s_mov_b64 exec, -1
    s_waitcnt vmcnt(0)
    ds_read_b128 v[56:59], v100
    ds_read_b128 v[60:63], v100 offset:256
    ds_read_b128 v[64:67], v101
    ds_read_b128 v[68:71], v101 offset:256
    s_setprio 3
    s_waitcnt lgkmcnt(0)
    buffer_load_dwordx4 v[96:97], s[40:43], s72 idxen offen lds
    buffer_load_dwordx4 v[98:99], s[40:43], 0 idxen offen offset:1024 lds
    s_cmp_eq_u32 s83, 1
    s_cbranch_scc1 .K2_T1
    s_cmp_eq_u32 s83, 2
    s_cbranch_scc1 .K2_T2
    s_branch .K2_T0
.K2_lo:
    ds_read_b128 v[8:11], v124 offset:0
    ds_read_b128 v[12:15], v125 offset:0
    ds_read_b128 v[16:19], v126 offset:0
    ds_read_b128 v[20:23], v127 offset:0
    s_waitcnt lgkmcnt(4)
    buffer_load_dwordx4 v[96:97], s[40:43], s72 idxen offen lds
    buffer_load_dwordx4 v[98:99], s[40:43], 0 idxen offen offset:1024 lds
    s_setprio 0
    ds_read_u16 v96, v102 offset:518
    ds_read_u16 v98, v102 offset:646
    ds_read_b128 v[24:27], v124 offset:4096
    ds_read_b128 v[28:31], v125 offset:4096
    ds_read_b128 v[32:35], v126 offset:4096
    ds_read_b128 v[36:39], v127 offset:4096
    s_setprio 1
    s_mov_b32 s78, 3216550459
    s_mov_b32 s79, 3216550459
    s_waitcnt lgkmcnt(6)
    s_waitcnt vmcnt(2)
    v_mfma_f32_16x16x32_bf16 v[40:43], v[56:59], v[8:11], 0
    v_mfma_f32_16x16x32_bf16 v[44:47], v[108:111], v[8:11], 0
    v_mfma_f32_16x16x32_bf16 v[40:43], v[60:63], v[12:15], v[40:43]
    v_mfma_f32_16x16x32_bf16 v[44:47], v[112:115], v[12:15], v[44:47]
    v_mfma_f32_16x16x32_bf16 v[40:43], v[64:67], v[16:19], v[40:43]
    v_mfma_f32_16x16x32_bf16 v[44:47], v[116:119], v[16:19], v[44:47]
    v_mfma_f32_16x16x32_bf16 v[40:43], v[68:71], v[20:23], v[40:43]
    v_mfma_f32_16x16x32_bf16 v[44:47], v[120:123], v[20:23], v[44:47]
    ds_read_b128 v[8:11], v124 offset:8192
    ds_read_b128 v[12:15], v125 offset:8192
    ds_read_b128 v[16:19], v126 offset:8192
    ds_read_b128 v[20:23], v127 offset:8192
    s_waitcnt lgkmcnt(4)
    v_mfma_f32_16x16x32_bf16 v[48:51], v[56:59], v[24:27], 0
    v_mfma_f32_16x16x32_bf16 v[52:55], v[108:111], v[24:27], 0
    v_mfma_f32_16x16x32_bf16 v[48:51], v[60:63], v[28:31], v[48:51]
    v_mfma_f32_16x16x32_bf16 v[52:55], v[112:115], v[28:31], v[52:55]
    v_mfma_f32_16x16x32_bf16 v[48:51], v[64:67], v[32:35], v[48:51]
    v_mfma_f32_16x16x32_bf16 v[52:55], v[116:119], v[32:35], v[52:55]
    v_mfma_f32_16x16x32_bf16 v[48:51], v[68:71], v[36:39], v[48:51]
    v_mfma_f32_16x16x32_bf16 v[52:55], v[120:123], v[36:39], v[52:55]
    v_pk_mul_f32 v[40:41], v[40:41], s[78:79]
    v_pk_mul_f32 v[42:43], v[42:43], s[78:79]
    v_cvt_pk_bf16_f32 v40, v40, v41
    v_cvt_pk_bf16_f32 v41, v42, v43
    v_pk_mul_f32 v[44:45], v[44:45], s[78:79]
    v_pk_mul_f32 v[46:47], v[46:47], s[78:79]
    v_cvt_pk_bf16_f32 v44, v44, v45
    v_cvt_pk_bf16_f32 v45, v46, v47
    ds_write_b64 v2, v[40:41] offset:0
    ds_write_b64 v2, v[44:45] offset:32
    s_waitcnt lgkmcnt(2)
    v_mfma_f32_16x16x32_bf16 v[40:43], v[56:59], v[8:11], 0
    v_mfma_f32_16x16x32_bf16 v[44:47], v[108:111], v[8:11], 0
    v_mfma_f32_16x16x32_bf16 v[40:43], v[60:63], v[12:15], v[40:43]
    v_mfma_f32_16x16x32_bf16 v[44:47], v[112:115], v[12:15], v[44:47]
    v_mfma_f32_16x16x32_bf16 v[40:43], v[64:67], v[16:19], v[40:43]
    v_mfma_f32_16x16x32_bf16 v[44:47], v[116:119], v[16:19], v[44:47]
    v_mfma_f32_16x16x32_bf16 v[40:43], v[68:71], v[20:23], v[40:43]
    v_mfma_f32_16x16x32_bf16 v[44:47], v[120:123], v[20:23], v[44:47]
    v_pk_mul_f32 v[48:49], v[48:49], s[78:79]
    v_pk_mul_f32 v[50:51], v[50:51], s[78:79]
    v_cvt_pk_bf16_f32 v48, v48, v49
    v_cvt_pk_bf16_f32 v49, v50, v51
    v_pk_mul_f32 v[52:53], v[52:53], s[78:79]
    v_pk_mul_f32 v[54:55], v[54:55], s[78:79]
    v_cvt_pk_bf16_f32 v52, v52, v53
    v_cvt_pk_bf16_f32 v53, v54, v55
    ds_write_b64 v2, v[48:49] offset:4352
    ds_write_b64 v2, v[52:53] offset:4384
    v_cmp_ne_u32 s[88:89], 0, v3
    v_cmp_eq_u32 s[90:91], v6, v3
    v_add_u32 v103, s74, v103
    v_mad_u32_u24 v100, v104, s68, v100
    v_mad_u32_u24 v101, v104, s68, v101
    s_and_b64 s[76:77], s[76:77], s[92:93]
    s_bcnt1_i32_b64 s73, s[76:77]
    s_lshl_b64 s[76:77], -2, s68
    s_and_b64 s[88:89], s[88:89], s[76:77]
    s_orn2_b64 s[84:85], s[90:91], s[88:89]
    s_mov_b64 s[86:87], s[84:85]
    s_ff1_i32_b64 s74, s[88:89]
    s_bitset1_b64 s[86:87], s74
    s_or_b32 s74, s66, s71
    s_cselect_b64 s[86:87], -1, s[86:87]
    s_or_b32 s77, s22, 5
    s_brev_b32 s77, s77
    s_mov_b32 s76, 0
    s_sub_u32 s74, 63, s69
    s_lshr_b64 s[76:77], s[76:77], s74
    s_or_b64 s[84:85], s[84:85], s[76:77]
    s_add_u32 s74, s68, 1
    s_bitset1_b64 s[84:85], s74
    s_mul_i32 s74, s73, 1056
    s_add_u32 s56, s56, s74
    s_mul_i32 s74, s73, 43
    s_lshr_b32 s74, s74, 7
    s_mul_i32 s76, s74, 816
    s_mul_i32 s74, s74, 3
    s_sub_u32 s83, s73, s74
    v_add_u32 v106, s76, v106
    s_cmp_gt_u32 s83, 0
    s_cselect_b32 s76, 816, 0
    s_cmp_gt_u32 s83, 1
    s_cselect_b32 s77, 816, 0
    v_add_u32 v6, s76, v106
    v_add_u32 v7, s77, v106
    v_mov_b64 v[48:49], 0
    v_mov_b64 v[50:51], 0
    v_mov_b64 v[52:53], 0
    v_mov_b64 v[54:55], 0
    v_pk_mul_f32 v[40:41], v[40:41], s[78:79]
    v_pk_mul_f32 v[42:43], v[42:43], s[78:79]
    v_cvt_pk_bf16_f32 v40, v40, v41
    v_cvt_pk_bf16_f32 v41, v42, v43
    v_pk_mul_f32 v[44:45], v[44:45], s[78:79]
    v_pk_mul_f32 v[46:47], v[46:47], s[78:79]
    v_cvt_pk_bf16_f32 v44, v44, v45
    v_cvt_pk_bf16_f32 v45, v46, v47
    s_mov_b32 exec_lo, 0x00ff00ff
    s_mov_b32 exec_hi, 0x00ff00ff
    ds_write_b64 v2, v[40:41] offset:8704
    ds_write_b64 v2, v[44:45] offset:8736
    s_mov_b64 exec, -1
    v_mov_b64 v[46:47], 0
    v_mov_b64 v[44:45], 0
    v_mov_b64 v[42:43], 0
    v_mov_b64 v[40:41], 0
    s_branch .K2_bd
.K2_w15:
.K2_top0:
    s_bitcmp1_b64 s[84:85], s68
    s_cbranch_scc1 .K2_rw0
.K2_W0:
    s_mov_b64 exec, s[58:59]
    ds_read_u16 v76, v106 offset:816
    ds_read_u16 v80, v106 offset:848
    s_mov_b64 exec, -1
.K2_aW0:
    v_rcp_f32 v32, v32
    v_rcp_f32 v33, v33
    v_rcp_f32 v34, v34
    v_rcp_f32 v35, v35
    v_rcp_f32 v36, v36
    v_rcp_f32 v37, v37
    v_rcp_f32 v38, v38
    v_rcp_f32 v39, v39
    v_pk_mul_f32 v[40:41], v[8:9], v[24:25]
    v_pk_mul_f32 v[42:43], v[10:11], v[26:27]
    v_pk_mul_f32 v[44:45], v[12:13], v[28:29]
    v_pk_mul_f32 v[46:47], v[14:15], v[30:31]
    v_pk_mul_f32 v[48:49], v[16:17], v[32:33]
    v_pk_mul_f32 v[50:51], v[18:19], v[34:35]
    v_pk_mul_f32 v[52:53], v[20:21], v[36:37]
    v_pk_mul_f32 v[54:55], v[22:23], v[38:39]
    s_waitcnt lgkmcnt(0)
.K2_T0:
    v_mfma_f32_16x16x32_bf16 v[8:11], v[56:59], v[76:79], 0
    v_lshl_add_u64 v[102:103], s[52:53], 0, v[102:103]
    v_mfma_f32_16x16x32_bf16 v[12:15], v[60:63], v[76:79], 0
    v_lshl_add_u64 v[100:101], v[104:105], 0, v[100:101]
    v_mfma_f32_16x16x32_bf16 v[16:19], v[64:67], v[80:83], 0
    ds_read_u16 v96, v102 offset:518
    ds_read_u16 v98, v102 offset:646
    v_mfma_f32_16x16x32_bf16 v[20:23], v[68:71], v[80:83], 0
    s_mov_b32 m0, s54
    v_exp_f32 v24, v8
    v_exp_f32 v25, v9
    v_exp_f32 v26, v10
    v_exp_f32 v27, v11
    v_exp_f32 v28, v12
    v_exp_f32 v29, v13
    v_exp_f32 v30, v14
    v_exp_f32 v31, v15
    v_exp_f32 v32, v16
    v_exp_f32 v33, v17
    v_exp_f32 v34, v18
    v_exp_f32 v35, v19
    v_exp_f32 v36, v20
    v_exp_f32 v37, v21
    v_exp_f32 v38, v22
    v_exp_f32 v39, v23
    v_cvt_pk_bf16_f32 v40, v40, v41
    v_cvt_pk_bf16_f32 v41, v42, v43
    v_mfma_f32_32x32x16_bf16 v[24:39], v[84:87], v[84:87], v[24:39]
    v_cvt_pk_bf16_f32 v42, v44, v45
    v_cvt_pk_bf16_f32 v43, v46, v47
    v_cvt_pk_bf16_f32 v44, v48, v49
    v_cvt_pk_bf16_f32 v45, v50, v51
    v_cvt_pk_bf16_f32 v46, v52, v53
    v_cvt_pk_bf16_f32 v47, v54, v55
    v_mfma_f32_16x16x32_bf16 v[88:91], v[72:75], v[40:43], v[88:91]
    s_waitcnt vmcnt(0)
    ds_read_b128 v[56:59], v100
    v_mfma_f32_16x16x32_bf16 v[92:95], v[72:75], v[44:47], v[92:95]
    ds_read_b128 v[60:63], v100 offset:256
    ds_read_b128 v[64:67], v101
    ds_read_b128 v[68:71], v101 offset:256
    ds_read_b64_tr_b16 v[72:73], v103
    ds_read_b64_tr_b16 v[74:75], v103 offset:256
    v_rcp_f32 v24, v24
    v_rcp_f32 v25, v25
    v_rcp_f32 v26, v26
    v_rcp_f32 v27, v27
    v_rcp_f32 v28, v28
    v_rcp_f32 v29, v29
    v_rcp_f32 v30, v30
    v_rcp_f32 v31, v31
    s_waitcnt lgkmcnt(2)
    buffer_load_dwordx4 v[96:97], s[40:43], s72 idxen offen lds
    buffer_load_dwordx4 v[98:99], s[40:43], 0 idxen offen offset:1024 lds
    s_bitcmp1_b64 s[86:87], s68
    s_cbranch_scc1 .K2_rf0
    s_mov_b32 m0, s55
    v_cvt_pk_bf16_f32 v107, v88, v92
    s_mov_b32 s55, s56
    v_mov_b32 v88, 0
    v_mov_b32 v92, 0
    ds_write_addtid_b32 v107 offset:49408
    s_add_u32 s56, s56, 1056
    s_add_u32 s68, s68, 1
.K2_top1:
    s_bitcmp1_b64 s[84:85], s68
    s_cbranch_scc1 .K2_rw1
.K2_W1:
    s_mov_b64 exec, s[58:59]
    ds_read_u16_d16_hi v78, v106 offset:1088
    ds_read_u16_d16_hi v82, v106 offset:1120
    s_mov_b64 exec, -1
.K2_aW1:
    v_rcp_f32 v32, v32
    v_rcp_f32 v33, v33
    v_rcp_f32 v34, v34
    v_rcp_f32 v35, v35
    v_rcp_f32 v36, v36
    v_rcp_f32 v37, v37
    v_rcp_f32 v38, v38
    v_rcp_f32 v39, v39
    v_pk_mul_f32 v[40:41], v[8:9], v[24:25]
    v_pk_mul_f32 v[42:43], v[10:11], v[26:27]
    v_pk_mul_f32 v[44:45], v[12:13], v[28:29]
    v_pk_mul_f32 v[46:47], v[14:15], v[30:31]
    v_pk_mul_f32 v[48:49], v[16:17], v[32:33]
    v_pk_mul_f32 v[50:51], v[18:19], v[34:35]
    v_pk_mul_f32 v[52:53], v[20:21], v[36:37]
    v_pk_mul_f32 v[54:55], v[22:23], v[38:39]
    s_waitcnt lgkmcnt(0)
.K2_T1:
    v_mfma_f32_16x16x32_bf16 v[8:11], v[56:59], v[76:79], 0
    v_lshl_add_u64 v[102:103], s[52:53], 0, v[102:103]
    v_mfma_f32_16x16x32_bf16 v[12:15], v[60:63], v[76:79], 0
    v_lshl_add_u64 v[100:101], v[104:105], 0, v[100:101]
    v_mfma_f32_16x16x32_bf16 v[16:19], v[64:67], v[80:83], 0
    ds_read_u16 v96, v102 offset:518
    ds_read_u16 v98, v102 offset:646
    v_mfma_f32_16x16x32_bf16 v[20:23], v[68:71], v[80:83], 0
    s_mov_b32 m0, s54
    v_exp_f32 v24, v8
    v_exp_f32 v25, v9
    v_exp_f32 v26, v10
    v_exp_f32 v27, v11
    v_exp_f32 v28, v12
    v_exp_f32 v29, v13
    v_exp_f32 v30, v14
    v_exp_f32 v31, v15
    v_exp_f32 v32, v16
    v_exp_f32 v33, v17
    v_exp_f32 v34, v18
    v_exp_f32 v35, v19
    v_exp_f32 v36, v20
    v_exp_f32 v37, v21
    v_exp_f32 v38, v22
    v_exp_f32 v39, v23
    v_cvt_pk_bf16_f32 v40, v40, v41
    v_cvt_pk_bf16_f32 v41, v42, v43
    v_mfma_f32_32x32x16_bf16 v[24:39], v[84:87], v[84:87], v[24:39]
    v_cvt_pk_bf16_f32 v42, v44, v45
    v_cvt_pk_bf16_f32 v43, v46, v47
    v_cvt_pk_bf16_f32 v44, v48, v49
    v_cvt_pk_bf16_f32 v45, v50, v51
    v_cvt_pk_bf16_f32 v46, v52, v53
    v_cvt_pk_bf16_f32 v47, v54, v55
    v_mfma_f32_16x16x32_bf16 v[88:91], v[72:75], v[40:43], v[88:91]
    s_waitcnt vmcnt(0)
    ds_read_b128 v[56:59], v100
    v_mfma_f32_16x16x32_bf16 v[92:95], v[72:75], v[44:47], v[92:95]
    ds_read_b128 v[60:63], v100 offset:256
    ds_read_b128 v[64:67], v101
    ds_read_b128 v[68:71], v101 offset:256
    ds_read_b64_tr_b16 v[72:73], v103
    ds_read_b64_tr_b16 v[74:75], v103 offset:256
    v_rcp_f32 v24, v24
    v_rcp_f32 v25, v25
    v_rcp_f32 v26, v26
    v_rcp_f32 v27, v27
    v_rcp_f32 v28, v28
    v_rcp_f32 v29, v29
    v_rcp_f32 v30, v30
    v_rcp_f32 v31, v31
    s_waitcnt lgkmcnt(2)
    buffer_load_dwordx4 v[96:97], s[40:43], s72 idxen offen lds
    buffer_load_dwordx4 v[98:99], s[40:43], 0 idxen offen offset:1024 lds
    s_bitcmp1_b64 s[86:87], s68
    s_cbranch_scc1 .K2_rf1
    s_mov_b32 m0, s55
    v_cvt_pk_bf16_f32 v107, v89, v93
    s_mov_b32 s55, s56
    v_mov_b32 v89, 0
    v_mov_b32 v93, 0
    ds_write_addtid_b32 v107 offset:49408
    s_add_u32 s56, s56, 1056
    s_add_u32 s68, s68, 1
.K2_top2:
    s_bitcmp1_b64 s[84:85], s68
    s_cbranch_scc1 .K2_rw2
.K2_W2:
    s_mov_b64 exec, s[58:59]
    ds_read_u16 v77, v106 offset:1360
    ds_read_u16 v81, v106 offset:1392
    s_mov_b64 exec, -1
.K2_aW2:
    v_rcp_f32 v32, v32
    v_rcp_f32 v33, v33
    v_rcp_f32 v34, v34
    v_rcp_f32 v35, v35
    v_rcp_f32 v36, v36
    v_rcp_f32 v37, v37
    v_rcp_f32 v38, v38
    v_rcp_f32 v39, v39
    v_pk_mul_f32 v[40:41], v[8:9], v[24:25]
    v_pk_mul_f32 v[42:43], v[10:11], v[26:27]
    v_pk_mul_f32 v[44:45], v[12:13], v[28:29]
    v_pk_mul_f32 v[46:47], v[14:15], v[30:31]
    v_pk_mul_f32 v[48:49], v[16:17], v[32:33]
    v_pk_mul_f32 v[50:51], v[18:19], v[34:35]
    v_pk_mul_f32 v[52:53], v[20:21], v[36:37]
    v_pk_mul_f32 v[54:55], v[22:23], v[38:39]
    s_waitcnt lgkmcnt(0)
.K2_T2:
    v_mfma_f32_16x16x32_bf16 v[8:11], v[56:59], v[76:79], 0
    v_lshl_add_u64 v[102:103], s[52:53], 0, v[102:103]
    v_mfma_f32_16x16x32_bf16 v[12:15], v[60:63], v[76:79], 0
    v_lshl_add_u64 v[100:101], v[104:105], 0, v[100:101]
    v_mfma_f32_16x16x32_bf16 v[16:19], v[64:67], v[80:83], 0
    ds_read_u16 v96, v102 offset:518
    ds_read_u16 v98, v102 offset:646
    v_mfma_f32_16x16x32_bf16 v[20:23], v[68:71], v[80:83], 0
    s_mov_b32 m0, s54
    v_exp_f32 v24, v8
    v_exp_f32 v25, v9
    v_exp_f32 v26, v10
    v_exp_f32 v27, v11
    v_exp_f32 v28, v12
    v_exp_f32 v29, v13
    v_exp_f32 v30, v14
    v_exp_f32 v31, v15
    v_exp_f32 v32, v16
    v_exp_f32 v33, v17
    v_exp_f32 v34, v18
    v_exp_f32 v35, v19
    v_exp_f32 v36, v20
    v_exp_f32 v37, v21
    v_exp_f32 v38, v22
    v_exp_f32 v39, v23
    v_cvt_pk_bf16_f32 v40, v40, v41
    v_cvt_pk_bf16_f32 v41, v42, v43
    v_mfma_f32_32x32x16_bf16 v[24:39], v[84:87], v[84:87], v[24:39]
    v_cvt_pk_bf16_f32 v42, v44, v45
    v_cvt_pk_bf16_f32 v43, v46, v47
    v_cvt_pk_bf16_f32 v44, v48, v49
    v_cvt_pk_bf16_f32 v45, v50, v51
    v_cvt_pk_bf16_f32 v46, v52, v53
    v_cvt_pk_bf16_f32 v47, v54, v55
    v_mfma_f32_16x16x32_bf16 v[88:91], v[72:75], v[40:43], v[88:91]
    s_waitcnt vmcnt(0)
    ds_read_b128 v[56:59], v100
    v_mfma_f32_16x16x32_bf16 v[92:95], v[72:75], v[44:47], v[92:95]
    ds_read_b128 v[60:63], v100 offset:256
    ds_read_b128 v[64:67], v101
    ds_read_b128 v[68:71], v101 offset:256
    ds_read_b64_tr_b16 v[72:73], v103
    ds_read_b64_tr_b16 v[74:75], v103 offset:256
    v_rcp_f32 v24, v24
    v_rcp_f32 v25, v25
    v_rcp_f32 v26, v26
    v_rcp_f32 v27, v27
    v_rcp_f32 v28, v28
    v_rcp_f32 v29, v29
    v_rcp_f32 v30, v30
    v_rcp_f32 v31, v31
    s_waitcnt lgkmcnt(2)
    buffer_load_dwordx4 v[96:97], s[40:43], s72 idxen offen lds
    buffer_load_dwordx4 v[98:99], s[40:43], 0 idxen offen offset:1024 lds
    s_bitcmp1_b64 s[86:87], s68
    s_cbranch_scc1 .K2_rf2
    s_mov_b32 m0, s55
    v_cvt_pk_bf16_f32 v107, v90, v94
    s_mov_b32 s55, s56
    v_mov_b32 v90, 0
    v_mov_b32 v94, 0
    ds_write_addtid_b32 v107 offset:49408
    s_add_u32 s56, s56, 1056
    v_add_u32 v106, 816, v106
    s_add_u32 s68, s68, 1
    s_branch .K2_top0
.K2_rw0:
    s_mov_b32 s70, 0
    s_cmp_ge_u32 s68, s69
    s_cbranch_scc1 .K2_tail
    s_sub_u32 s73, s69, s68
    s_cmp_gt_u32 s73, 2
    s_cselect_b32 s42, s42, 0
    s_min_u32 s73, s73, 31
    s_lshr_b32 s73, s22, s73
    s_bcnt1_i32_b32 s73, s73
    s_cbranch_scc0 .K2_rwa0
    s_setprio 2
    s_cmp_eq_u32 s73, 1
    s_cbranch_scc1 .K2_rwa0
    s_setprio 1
    s_cmp_eq_u32 s73, 2
    s_cbranch_scc1 .K2_rwa0
    s_setprio 0
.K2_rwa0:
    s_bitcmp1_b64 s[88:89], s68
    s_cbranch_scc0 .K2_aW0
    s_bitcmp1_b64 s[90:91], s68
    s_cbranch_scc0 .K2_W0
    s_mov_b64 exec, s[58:59]
    ds_read_u16_d16_hi v78, v106 offset:1088
    ds_read_u16_d16_hi v82, v106 offset:1120
    s_branch .K2_W0
.K2_rw1:
    s_mov_b32 s70, 1
    s_cmp_ge_u32 s68, s69
    s_cbranch_scc1 .K2_tail
    s_sub_u32 s73, s69, s68
    s_cmp_gt_u32 s73, 2
    s_cselect_b32 s42, s42, 0
    s_min_u32 s73, s73, 31
    s_lshr_b32 s73, s22, s73
    s_bcnt1_i32_b32 s73, s73
    s_cbranch_scc0 .K2_rwa1
    s_setprio 2
    s_cmp_eq_u32 s73, 1
    s_cbranch_scc1 .K2_rwa1
    s_setprio 1
    s_cmp_eq_u32 s73, 2
    s_cbranch_scc1 .K2_rwa1
    s_setprio 0
.K2_rwa1:
    s_bitcmp1_b64 s[88:89], s68
    s_cbranch_scc0 .K2_aW1
    s_bitcmp1_b64 s[90:91], s68
    s_cbranch_scc0 .K2_W1
    s_mov_b64 exec, s[58:59]
    ds_read_u16 v77, v106 offset:1360
    ds_read_u16 v81, v106 offset:1392
    s_branch .K2_W1
.K2_rw2:
    s_mov_b32 s70, 2
    s_cmp_ge_u32 s68, s69
    s_cbranch_scc1 .K2_tail
    s_sub_u32 s73, s69, s68
    s_cmp_gt_u32 s73, 2
    s_cselect_b32 s42, s42, 0
    s_min_u32 s73, s73, 31
    s_lshr_b32 s73, s22, s73
    s_bcnt1_i32_b32 s73, s73
    s_cbranch_scc0 .K2_rwa2
    s_setprio 2
    s_cmp_eq_u32 s73, 1
    s_cbranch_scc1 .K2_rwa2
    s_setprio 1
    s_cmp_eq_u32 s73, 2
    s_cbranch_scc1 .K2_rwa2
    s_setprio 0
.K2_rwa2:
    s_bitcmp1_b64 s[88:89], s68
    s_cbranch_scc0 .K2_aW2
    s_bitcmp1_b64 s[90:91], s68
    s_cbranch_scc0 .K2_W2
    s_mov_b64 exec, s[58:59]
    ds_read_u16 v76, v106 offset:1632
    ds_read_u16 v80, v106 offset:1664
    s_branch .K2_W2
.K2_rf0:
    s_bitcmp1_b64 s[88:89], s68
    s_cbranch_scc0 .K2_ex0
.K2_gf0:
    s_mov_b32 m0, s55
    s_or_b32 s73, s66, s71
    s_cbranch_scc0 .K2_gfa0
    s_mul_i32 s73, s2, 84480
    s_add_u32 s73, s73, 16777216
    s_add_u32 s28, s24, s73
    s_addc_u32 s29, s25, 0
    s_mov_b32 s30, 84480
    s_mov_b32 s31, 0x00020000
    s_lshl_b32 s73, s55, 1
    v_lshlrev_b32 v4, 3, v1
    s_cmp_eq_u32 s66, 0
    s_cbranch_scc1 .K2_gfb0
    buffer_load_dwordx2 v[2:3], v4, s[28:31], s73 offen sc0 sc1
    s_waitcnt vmcnt(0)
    v_add_f32 v88, v88, v2
    v_add_f32 v92, v92, v3
.K2_gfb0:
    v_mov_b32 v6, v88
    v_mov_b32 v7, v92
    buffer_store_dwordx2 v[6:7], v4, s[28:31], s73 offen sc0 sc1
    s_waitcnt vmcnt(0)
.K2_gfa0:
    v_cvt_pk_bf16_f32 v107, v88, v92
    s_mov_b32 s55, s56
    v_mov_b32 v88, 0
    v_mov_b32 v92, 0
    ds_write_addtid_b32 v107 offset:49408
    s_add_u32 s56, s56, 1056
    s_lshl_b32 s73, s3, 2
    v_mov_b32 v2, s73
    ds_write_b32 v2, v106 offset:23872
    s_cmp_lg_u32 s57, 0
    s_cbranch_scc1 .K2_done
    s_bitcmp1_b64 s[90:91], s68
    s_bitset0_b64 s[90:91], s68
    s_cbranch_scc1 .K2_gf1
.K2_ex1:
    s_mov_b32 s70, 1
    s_cmp_ge_u32 s68, s69
    s_cbranch_scc1 .K2_trail
    s_add_u32 s68, s68, 1
    s_branch .K2_top1
.K2_rf1:
    s_bitcmp1_b64 s[88:89], s68
    s_cbranch_scc0 .K2_ex1
.K2_gf1:
    s_mov_b32 m0, s55
    s_or_b32 s73, s66, s71
    s_cbranch_scc0 .K2_gfa1
    s_mul_i32 s73, s2, 84480
    s_add_u32 s73, s73, 16777216
    s_add_u32 s28, s24, s73
    s_addc_u32 s29, s25, 0
    s_mov_b32 s30, 84480
    s_mov_b32 s31, 0x00020000
    s_lshl_b32 s73, s55, 1
    v_lshlrev_b32 v4, 3, v1
    s_cmp_eq_u32 s66, 0
    s_cbranch_scc1 .K2_gfb1
    buffer_load_dwordx2 v[2:3], v4, s[28:31], s73 offen sc0 sc1
    s_waitcnt vmcnt(0)
    v_add_f32 v89, v89, v2
    v_add_f32 v93, v93, v3
.K2_gfb1:
    v_mov_b32 v6, v89
    v_mov_b32 v7, v93
    buffer_store_dwordx2 v[6:7], v4, s[28:31], s73 offen sc0 sc1
    s_waitcnt vmcnt(0)
.K2_gfa1:
    v_cvt_pk_bf16_f32 v107, v89, v93
    s_mov_b32 s55, s56
    v_mov_b32 v89, 0
    v_mov_b32 v93, 0
    ds_write_addtid_b32 v107 offset:49408
    s_add_u32 s56, s56, 1056
    s_lshl_b32 s73, s3, 2
    v_mov_b32 v2, s73
    ds_write_b32 v2, v106 offset:23872
    s_cmp_lg_u32 s57, 0
    s_cbranch_scc1 .K2_done
    s_bitcmp1_b64 s[90:91], s68
    s_bitset0_b64 s[90:91], s68
    s_cbranch_scc1 .K2_gf2
.K2_ex2:
    s_mov_b32 s70, 2
    s_cmp_ge_u32 s68, s69
    s_cbranch_scc1 .K2_trail
    s_add_u32 s68, s68, 1
    s_branch .K2_top2
.K2_rf2:
    s_bitcmp1_b64 s[88:89], s68
    s_cbranch_scc0 .K2_ex2
.K2_gf2:
    s_mov_b32 m0, s55
    s_or_b32 s73, s66, s71
    s_cbranch_scc0 .K2_gfa2
    s_mul_i32 s73, s2, 84480
    s_add_u32 s73, s73, 16777216
    s_add_u32 s28, s24, s73
    s_addc_u32 s29, s25, 0
    s_mov_b32 s30, 84480
    s_mov_b32 s31, 0x00020000
    s_lshl_b32 s73, s55, 1
    v_lshlrev_b32 v4, 3, v1
    s_cmp_eq_u32 s66, 0
    s_cbranch_scc1 .K2_gfb2
    buffer_load_dwordx2 v[2:3], v4, s[28:31], s73 offen sc0 sc1
    s_waitcnt vmcnt(0)
    v_add_f32 v90, v90, v2
    v_add_f32 v94, v94, v3
.K2_gfb2:
    v_mov_b32 v6, v90
    v_mov_b32 v7, v94
    buffer_store_dwordx2 v[6:7], v4, s[28:31], s73 offen sc0 sc1
    s_waitcnt vmcnt(0)
.K2_gfa2:
    v_cvt_pk_bf16_f32 v107, v90, v94
    s_mov_b32 s55, s56
    v_mov_b32 v90, 0
    v_mov_b32 v94, 0
    ds_write_addtid_b32 v107 offset:49408
    s_add_u32 s56, s56, 1056
    v_add_u32 v106, 816, v106
    s_lshl_b32 s73, s3, 2
    v_mov_b32 v2, s73
    ds_write_b32 v2, v106 offset:23872
    s_cmp_lg_u32 s57, 0
    s_cbranch_scc1 .K2_done
    s_bitcmp1_b64 s[90:91], s68
    s_bitset0_b64 s[90:91], s68
    s_cbranch_scc1 .K2_gf0
.K2_ex0:
    s_mov_b32 s70, 0
    s_cmp_ge_u32 s68, s69
    s_cbranch_scc1 .K2_trail
    s_add_u32 s68, s68, 1
    s_branch .K2_top0
.K2_over:
    s_mov_b32 s65, 6
    s_setprio 0
    s_waitcnt vmcnt(0) lgkmcnt(0)
    s_barrier
    s_branch .K2_again
.K2_tail:
    v_rcp_f32 v32, v32
    v_rcp_f32 v33, v33
    v_rcp_f32 v34, v34
    v_rcp_f32 v35, v35
    v_rcp_f32 v36, v36
    v_rcp_f32 v37, v37
    v_rcp_f32 v38, v38
    v_rcp_f32 v39, v39
    v_pk_mul_f32 v[40:41], v[8:9], v[24:25]
    v_pk_mul_f32 v[42:43], v[10:11], v[26:27]
    v_pk_mul_f32 v[44:45], v[12:13], v[28:29]
    v_pk_mul_f32 v[46:47], v[14:15], v[30:31]
    v_pk_mul_f32 v[48:49], v[16:17], v[32:33]
    v_pk_mul_f32 v[50:51], v[18:19], v[34:35]
    v_pk_mul_f32 v[52:53], v[20:21], v[36:37]
    v_pk_mul_f32 v[54:55], v[22:23], v[38:39]
    v_cvt_pk_bf16_f32 v40, v40, v41
    v_cvt_pk_bf16_f32 v41, v42, v43
    v_cvt_pk_bf16_f32 v42, v44, v45
    v_cvt_pk_bf16_f32 v43, v46, v47
    v_cvt_pk_bf16_f32 v44, v48, v49
    v_cvt_pk_bf16_f32 v45, v50, v51
    v_cvt_pk_bf16_f32 v46, v52, v53
    v_cvt_pk_bf16_f32 v47, v54, v55
    s_waitcnt lgkmcnt(0)
    v_mfma_f32_16x16x32_bf16 v[88:91], v[72:75], v[40:43], v[88:91]
    v_mfma_f32_16x16x32_bf16 v[92:95], v[72:75], v[44:47], v[92:95]
    s_nop 7
    s_cmp_eq_u32 s70, 1
    s_cbranch_scc1 .K2_rf1
    s_cmp_eq_u32 s70, 2
    s_cbranch_scc1 .K2_rf2
    s_branch .K2_rf0
.K2_trail:
    s_cmp_lt_u32 s3, 4
    s_cbranch_scc1 .K2_done
    s_lshl_b32 s73, s3, 2
    v_mov_b32 v2, s73
    s_lshr_b32 s73, s3, 2
    s_mul_i32 s73, s73, -1056
    s_lshl2_add_u32 s73, s63, s73
    s_add_u32 m0, s73, 45408
    s_mov_b32 s57, 1
.K2_poll:
    ds_read_b32 v3, v2 offset:23856
    ds_read_addtid_b32 v107 offset:49408
    s_waitcnt lgkmcnt(0)
    v_readfirstlane_b32 s73, v3
    s_cmp_lg_u32 s73, 0
    s_cbranch_scc1 .K2_got
    s_sleep 1
    s_branch .K2_poll
.K2_got:
    v_lshlrev_b32 v2, 16, v107
    v_and_b32 v107, 0xffff0000, v107
    v_add_f32 v88, v88, v2
    v_add_f32 v92, v92, v107
    v_add_f32 v89, v89, v2
    v_add_f32 v93, v93, v107
    v_add_f32 v90, v90, v2
    v_add_f32 v94, v94, v107
    s_cmp_eq_u32 s70, 1
    s_cbranch_scc1 .K2_gf1
    s_cmp_eq_u32 s70, 2
    s_cbranch_scc1 .K2_gf2
    s_branch .K2_gf0
.K2_done:
    s_cmp_ge_u32 s3, 8
    s_cbranch_scc1 .K2_bar
    s_cmp_lg_u32 s71, 0
    s_cbranch_scc1 .K2_bar
    s_setprio 0
    s_load_dwordx2 s[44:45], s[0:1], 64
    v_mov_b64 v[118:119], 0
    s_cmp_ge_u32 s3, 8
    s_cbranch_scc1 .K2_eno
    v_and_b32 v2, 15, v1
    s_mov_b32 s73, 153600
    v_and_b32 v3, 48, v1
    s_lshl_b32 s74, s3, 5
    v_lshlrev_b32 v4, 4, v2
    s_mov_b32 s76, 0x24922492
    v_lshl_or_b32 v5, v2, 8, v3
    s_mov_b32 s77, s76
    v_xad_u32 v108, v5, v4, s73
    s_mov_b32 s78, 0x92499249
    v_lshrrev_b32 v5, 1, v3
    s_mov_b32 s79, s78
    v_xor_b32 v4, s74, v4
    s_movk_i32 s74, 1056
    v_lshl_or_b32 v119, v2, 8, v5
    s_mov_b32 vcc_lo, 0x49244924
    v_add_u32 v3, 49408, v3
    s_mov_b32 vcc_hi, vcc_lo
    v_xad_u32 v115, v119, v4, s73
    s_add_u32 s73, s3, 3
    v_mad_u32_u24 v4, v2, s74, v3
    s_and_b32 s73, s73, 7
    v_xor_b32 v109, 64, v108
    s_lshl_b32 s74, s73, 2
    v_add_u32 v5, 64, v4
    s_lshl_b32 s73, s73, 4
    v_xor_b32 v110, 128, v108
    s_lshr_b32 s74, 0x13570246, s74
    v_cndmask_b32 v112, v4, v5, s[76:77]
    s_and_b32 s74, s74, 15
    v_cndmask_b32 v113, v4, v5, s[78:79]
    s_lshr_b32 s74, 0x8040201, s74
    v_cndmask_b32 v114, v4, v5, vcc
    s_pack_ll_b32_b16 s76, s74, s74
    v_add_u32 v2, s73, v2
    s_mov_b32 s77, s76
    v_mul_u32_u24 v4, 43, v2
    s_movk_i32 s74, 864
    v_add_u32 v5, 64, v3
    v_lshrrev_b32 v4, 7, v4
    v_cndmask_b32 v3, v5, v3, s[76:77]
    v_add_lshl_u32 v116, v2, v4, 2
    v_mad_u32_u24 v3, v4, s74, v3
    ds_read_b32 v116, v116 offset:48144
    v_xor_b32 v111, 192, v108
    v_lshl_add_u32 v117, v2, 6, v3
    v_lshlrev_b32 v118, 1, v2
.K2_eno:
    s_mov_b32 s46, 2620000
    s_mov_b32 s47, 0x00020000
    v_mov_b32 v2, 23936
    v_mov_b32 v3, 1
    s_mov_b64 exec, 1
    ds_add_u32 v2, v3
    s_mov_b64 exec, -1
    v_lshlrev_b32 v94, 4, v1
    s_lshl_b32 s73, s3, 12
    s_add_u32 s73, s73, 9437184
    s_add_u32 s75, s73, 32768
    s_mov_b32 s82, 9502720
    buffer_load_dwordx4 v[4:7], v94, s[24:27], s73 offen offset:0
    buffer_load_dwordx4 v[8:11], v94, s[24:27], s73 offen offset:1024
    buffer_load_dwordx4 v[120:123], v94, s[24:27], s73 offen offset:2048
    buffer_load_dwordx4 v[124:127], v94, s[24:27], s73 offen offset:3072
    buffer_load_dwordx4 v[56:59], v94, s[24:27], s75 offen offset:0
    buffer_load_dwordx4 v[60:63], v94, s[24:27], s75 offen offset:1024
    buffer_load_dwordx4 v[64:67], v94, s[24:27], s75 offen offset:2048
    buffer_load_dwordx4 v[68:71], v94, s[24:27], s75 offen offset:3072
    s_waitcnt lgkmcnt(0)
    ds_read_b64 v[88:89], v115 offset:0
    ds_read_b64 v[90:91], v115 offset:4096
    ds_read_b64 v[92:93], v115 offset:8192
    ds_read_b128 v[24:27], v108 offset:0
    ds_read_b128 v[28:31], v109 offset:0
    ds_read_b128 v[32:35], v110 offset:0
    ds_read_b128 v[36:39], v111 offset:0
    ds_read_b128 v[40:43], v108 offset:4096
    ds_read_b128 v[44:47], v109 offset:4096
    ds_read_b128 v[48:51], v110 offset:4096
    ds_read_b128 v[52:55], v111 offset:4096
    ds_read_b128 v[72:75], v108 offset:8192
    ds_read_b128 v[76:79], v109 offset:8192
    ds_read_b128 v[80:83], v110 offset:8192
    ds_read_b128 v[84:87], v111 offset:8192
    s_mov_b32 s76, 0xffff0000
    s_add_u32 s73, s3, 3
    s_and_b32 s73, s73, 7
    s_lshl_b32 s73, s73, 4
    s_mul_i32 s83, s61, 3
    s_sub_u32 s83, s83, s73
    s_min_i32 s83, s83, 16
    s_bfm_b64 s[84:85], s83, 0
    s_mul_i32 s83, s60, 6
    s_add_u32 s83, s83, 2560000
    s_lshl_b32 s77, s3, 5
    s_lshl_b32 s73, s60, 8
    s_add_u32 s73, s73, s77
    s_add_u32 s77, s73, 4096
    s_add_u32 s78, s73, 8192
    s_sub_u32 s79, s61, 32
    s_bfm_b32 s79, s79, 0
    s_pack_ll_b32_b16 vcc_lo, s79, s79
    s_mov_b32 vcc_hi, vcc_lo
    s_mov_b32 s80, 3216550459
    s_mov_b32 s81, 3216550459
    s_mov_b32 s86, 3207688728
    s_mov_b32 s87, 3207688728
    s_mov_b32 s88, 1.0
    s_mov_b32 s89, 1.0
    s_waitcnt lgkmcnt(12)
    v_lshlrev_b32 v12, 16, v88
    v_and_b32 v13, s76, v88
    v_lshlrev_b32 v14, 16, v89
    v_and_b32 v15, s76, v89
    v_lshlrev_b32 v16, 16, v90
    v_and_b32 v17, s76, v90
    v_lshlrev_b32 v18, 16, v91
    v_and_b32 v19, s76, v91
    v_lshlrev_b32 v20, 16, v92
    v_and_b32 v21, s76, v92
    v_lshlrev_b32 v22, 16, v93
    v_and_b32 v23, s76, v93
    s_waitcnt vmcnt(4) lgkmcnt(0)
    v_mfma_f32_16x16x32_bf16 v[96:99], v[4:7], v[24:27], 0
    v_mfma_f32_16x16x32_bf16 v[100:103], v[4:7], v[40:43], 0
    v_mfma_f32_16x16x32_bf16 v[104:107], v[4:7], v[72:75], 0
    v_mfma_f32_16x16x32_bf16 v[96:99], v[8:11], v[28:31], v[96:99]
    v_mfma_f32_16x16x32_bf16 v[100:103], v[8:11], v[44:47], v[100:103]
    v_mfma_f32_16x16x32_bf16 v[104:107], v[8:11], v[76:79], v[104:107]
    v_mfma_f32_16x16x32_bf16 v[96:99], v[120:123], v[32:35], v[96:99]
    v_mfma_f32_16x16x32_bf16 v[100:103], v[120:123], v[48:51], v[100:103]
    v_mfma_f32_16x16x32_bf16 v[104:107], v[120:123], v[80:83], v[104:107]
    v_mfma_f32_16x16x32_bf16 v[96:99], v[124:127], v[36:39], v[96:99]
    v_mfma_f32_16x16x32_bf16 v[100:103], v[124:127], v[52:55], v[100:103]
    v_mfma_f32_16x16x32_bf16 v[104:107], v[124:127], v[84:87], v[104:107]
    buffer_load_dwordx4 v[4:7], v94, s[24:27], s82 offen offset:0
    buffer_load_dwordx4 v[8:11], v94, s[24:27], s82 offen offset:1024
    buffer_load_dwordx4 v[120:123], v94, s[24:27], s82 offen offset:2048
    buffer_load_dwordx4 v[124:127], v94, s[24:27], s82 offen offset:3072
    s_nop 1
    v_pk_mul_f32 v[96:97], v[96:97], s[80:81]
    v_pk_mul_f32 v[98:99], v[98:99], s[80:81]
    v_pk_mul_f32 v[100:101], v[100:101], s[80:81]
    v_pk_mul_f32 v[102:103], v[102:103], s[80:81]
    v_pk_mul_f32 v[104:105], v[104:105], s[80:81]
    v_pk_mul_f32 v[106:107], v[106:107], s[80:81]
.K2_pd:
    ds_read_b32 v3, v2
    s_waitcnt lgkmcnt(0)
    v_readfirstlane_b32 s76, v3
    s_cmp_ge_u32 s76, 8
    s_cbranch_scc1 .K2_pdd
    s_sleep 2
    s_branch .K2_pd
.K2_pdd:
    ds_read_b128 v[72:75], v114 offset:33792
    ds_read_b128 v[76:79], v114 offset:34048
    ds_read_b128 v[80:83], v114 offset:34304
    ds_read_b128 v[84:87], v114 offset:34560
    ds_read_b128 v[40:43], v113 offset:16896
    ds_read_b128 v[44:47], v113 offset:17152
    ds_read_b128 v[48:51], v113 offset:17408
    ds_read_b128 v[52:55], v113 offset:17664
    s_waitcnt vmcnt(4)
    s_waitcnt lgkmcnt(7)
    v_mfma_f32_16x16x32_bf16 v[104:107], v[56:59], v[72:75], v[104:107]
    s_waitcnt lgkmcnt(6)
    v_mfma_f32_16x16x32_bf16 v[104:107], v[60:63], v[76:79], v[104:107]
    s_waitcnt lgkmcnt(5)
    v_mfma_f32_16x16x32_bf16 v[104:107], v[64:67], v[80:83], v[104:107]
    s_waitcnt lgkmcnt(4)
    v_mfma_f32_16x16x32_bf16 v[104:107], v[68:71], v[84:87], v[104:107]
    s_waitcnt lgkmcnt(3)
    v_mfma_f32_16x16x32_bf16 v[100:103], v[56:59], v[40:43], v[100:103]
    s_waitcnt lgkmcnt(2)
    v_mfma_f32_16x16x32_bf16 v[100:103], v[60:63], v[44:47], v[100:103]
    s_waitcnt lgkmcnt(1)
    v_mfma_f32_16x16x32_bf16 v[100:103], v[64:67], v[48:51], v[100:103]
    s_waitcnt lgkmcnt(0)
    v_mfma_f32_16x16x32_bf16 v[100:103], v[68:71], v[52:55], v[100:103]
    v_exp_f32 v88, v104
    v_exp_f32 v89, v105
    v_exp_f32 v90, v106
    v_exp_f32 v91, v107
    v_pk_mul_f32 v[104:105], v[104:105], s[86:87]
    v_pk_mul_f32 v[106:107], v[106:107], s[86:87]
    v_pk_add_f32 v[88:89], v[88:89], s[88:89]
    v_pk_add_f32 v[90:91], v[90:91], s[88:89]
    v_rcp_f32 v88, v88
    v_rcp_f32 v89, v89
    v_rcp_f32 v90, v90
    v_rcp_f32 v91, v91
    v_pk_fma_f32 v[20:21], v[104:105], v[88:89], v[20:21]
    v_pk_fma_f32 v[22:23], v[106:107], v[90:91], v[22:23]
    v_cvt_pk_bf16_f32 v20, v20, v21
    v_cvt_pk_bf16_f32 v21, v22, v23
    s_mov_b64 exec, vcc
    buffer_store_dwordx2 v[20:21], v119, s[44:47], s78 offen
    s_mov_b64 exec, -1
    v_exp_f32 v88, v100
    v_exp_f32 v89, v101
    v_exp_f32 v90, v102
    v_exp_f32 v91, v103
    v_pk_mul_f32 v[100:101], v[100:101], s[86:87]
    v_pk_mul_f32 v[102:103], v[102:103], s[86:87]
    v_pk_add_f32 v[88:89], v[88:89], s[88:89]
    v_pk_add_f32 v[90:91], v[90:91], s[88:89]
    v_rcp_f32 v88, v88
    v_rcp_f32 v89, v89
    v_rcp_f32 v90, v90
    v_rcp_f32 v91, v91
    v_pk_fma_f32 v[16:17], v[100:101], v[88:89], v[16:17]
    v_pk_fma_f32 v[18:19], v[102:103], v[90:91], v[18:19]
    v_cvt_pk_bf16_f32 v16, v16, v17
    v_cvt_pk_bf16_f32 v17, v18, v19
    buffer_store_dwordx2 v[16:17], v119, s[44:47], s77 offen
    s_waitcnt vmcnt(2)
    s_cmp_ge_u32 s3, 5
    s_cbranch_scc1 .K2_fin2
    ds_read_b128 v[40:43], v117 offset:0
    ds_read_b128 v[44:47], v117 offset:256
    ds_read_b128 v[48:51], v117 offset:512
    ds_read_b128 v[52:55], v117 offset:768
    s_waitcnt lgkmcnt(3)
    v_mfma_f32_16x16x32_bf16 v[72:75], v[4:7], v[40:43], 0
    s_waitcnt lgkmcnt(2)
    v_mfma_f32_16x16x32_bf16 v[72:75], v[8:11], v[44:47], v[72:75]
    s_waitcnt lgkmcnt(1)
    v_mfma_f32_16x16x32_bf16 v[72:75], v[120:123], v[48:51], v[72:75]
    s_waitcnt lgkmcnt(0)
    v_mfma_f32_16x16x32_bf16 v[72:75], v[124:127], v[52:55], v[72:75]
    s_nop 7
    v_fmac_f32 v116, s86, v72
    v_cvt_pk_bf16_f32 v116, v116, v116
    s_mov_b64 exec, s[84:85]
    buffer_store_short v116, v118, s[44:47], s83 offen
    s_mov_b64 exec, -1
    s_barrier
    ds_read_b128 v[24:27], v112 offset:0
    ds_read_b128 v[28:31], v112 offset:256
    ds_read_b128 v[32:35], v112 offset:512
    ds_read_b128 v[36:39], v112 offset:768
    s_waitcnt lgkmcnt(3)
    v_mfma_f32_16x16x32_bf16 v[96:99], v[56:59], v[24:27], v[96:99]
    s_waitcnt lgkmcnt(2)
    v_mfma_f32_16x16x32_bf16 v[96:99], v[60:63], v[28:31], v[96:99]
    s_waitcnt lgkmcnt(1)
    v_mfma_f32_16x16x32_bf16 v[96:99], v[64:67], v[32:35], v[96:99]
    s_waitcnt lgkmcnt(0)
    v_mfma_f32_16x16x32_bf16 v[96:99], v[68:71], v[36:39], v[96:99]
    s_nop 7
    v_exp_f32 v88, v96
    v_exp_f32 v89, v97
    v_exp_f32 v90, v98
    v_exp_f32 v91, v99
    v_pk_mul_f32 v[96:97], v[96:97], s[86:87]
    v_pk_mul_f32 v[98:99], v[98:99], s[86:87]
    v_pk_add_f32 v[88:89], v[88:89], s[88:89]
    v_pk_add_f32 v[90:91], v[90:91], s[88:89]
    v_rcp_f32 v88, v88
    v_rcp_f32 v89, v89
    v_rcp_f32 v90, v90
    v_rcp_f32 v91, v91
    v_pk_fma_f32 v[12:13], v[96:97], v[88:89], v[12:13]
    v_pk_fma_f32 v[14:15], v[98:99], v[90:91], v[14:15]
    v_cvt_pk_bf16_f32 v12, v12, v13
    v_cvt_pk_bf16_f32 v13, v14, v15
    buffer_store_dwordx2 v[12:13], v119, s[44:47], s73 offen
    s_branch .K2_last
.K2_fin2:
    s_barrier
    ds_read_b128 v[24:27], v112 offset:0
    ds_read_b128 v[28:31], v112 offset:256
    ds_read_b128 v[32:35], v112 offset:512
    ds_read_b128 v[36:39], v112 offset:768
    ds_read_b128 v[40:43], v117 offset:0
    ds_read_b128 v[44:47], v117 offset:256
    ds_read_b128 v[48:51], v117 offset:512
    ds_read_b128 v[52:55], v117 offset:768
    s_waitcnt lgkmcnt(7)
    v_mfma_f32_16x16x32_bf16 v[96:99], v[56:59], v[24:27], v[96:99]
    s_waitcnt lgkmcnt(6)
    v_mfma_f32_16x16x32_bf16 v[96:99], v[60:63], v[28:31], v[96:99]
    s_waitcnt lgkmcnt(5)
    v_mfma_f32_16x16x32_bf16 v[96:99], v[64:67], v[32:35], v[96:99]
    s_waitcnt lgkmcnt(4)
    v_mfma_f32_16x16x32_bf16 v[96:99], v[68:71], v[36:39], v[96:99]
    s_waitcnt lgkmcnt(3)
    v_mfma_f32_16x16x32_bf16 v[72:75], v[4:7], v[40:43], 0
    s_waitcnt lgkmcnt(2)
    v_mfma_f32_16x16x32_bf16 v[72:75], v[8:11], v[44:47], v[72:75]
    s_waitcnt lgkmcnt(1)
    v_mfma_f32_16x16x32_bf16 v[72:75], v[120:123], v[48:51], v[72:75]
    s_waitcnt lgkmcnt(0)
    v_mfma_f32_16x16x32_bf16 v[72:75], v[124:127], v[52:55], v[72:75]
    v_exp_f32 v88, v96
    v_exp_f32 v89, v97
    v_exp_f32 v90, v98
    v_exp_f32 v91, v99
    v_pk_mul_f32 v[96:97], v[96:97], s[86:87]
    v_pk_mul_f32 v[98:99], v[98:99], s[86:87]
    v_pk_add_f32 v[88:89], v[88:89], s[88:89]
    v_pk_add_f32 v[90:91], v[90:91], s[88:89]
    v_rcp_f32 v88, v88
    v_rcp_f32 v89, v89
    v_rcp_f32 v90, v90
    v_rcp_f32 v91, v91
    v_pk_fma_f32 v[12:13], v[96:97], v[88:89], v[12:13]
    v_pk_fma_f32 v[14:15], v[98:99], v[90:91], v[14:15]
    v_cvt_pk_bf16_f32 v12, v12, v13
    v_cvt_pk_bf16_f32 v13, v14, v15
    buffer_store_dwordx2 v[12:13], v119, s[44:47], s73 offen
    v_fmac_f32 v116, s86, v72
    v_cvt_pk_bf16_f32 v116, v116, v116
    s_mov_b64 exec, s[84:85]
    buffer_store_short v116, v118, s[44:47], s83 offen
    s_branch .K2_last
.K2_bar:
    s_waitcnt vmcnt(0) lgkmcnt(0)
    s_barrier
    s_cmp_eq_u32 s71, 0
    s_cbranch_scc1 .K2_last
    s_add_u32 s64, s64, s65
    s_mov_b32 s66, 1
    s_setprio 0
    s_branch .K2_again
.K2_last:
.K2_end:
    s_endpgm

.section .rodata,"a"
.p2align 6
.amdhsa_kernel egnn_prep_kernel
  .amdhsa_next_free_vgpr 152
  .amdhsa_next_free_sgpr 102
  .amdhsa_accum_offset 152
  .amdhsa_group_segment_fixed_size 0
  .amdhsa_kernarg_size 88
  .amdhsa_user_sgpr_count 2
  .amdhsa_user_sgpr_kernarg_segment_ptr 1
  .amdhsa_system_sgpr_workgroup_id_x 1
.end_amdhsa_kernel
.p2align 6
.amdhsa_kernel egnn_main_kernel
  .amdhsa_next_free_vgpr 128
  .amdhsa_next_free_sgpr 102
  .amdhsa_accum_offset 128
  .amdhsa_group_segment_fixed_size 0
  .amdhsa_kernarg_size 88
  .amdhsa_user_sgpr_count 2
  .amdhsa_user_sgpr_kernarg_segment_ptr 1
  .amdhsa_system_sgpr_workgroup_id_x 1
.end_amdhsa_kernel
```
